```python
import torch

def _softmax(x, axis=-1):
    return torch.softmax(x, dim=axis)
def _gelu(x):
    return torch.nn.functional.gelu(x, approximate="tanh")
def _silu(x):
    return torch.nn.functional.silu(x)
def _sigmoid(x):
    return torch.sigmoid(x)
def _layernorm(x, axis=-1, eps=1e-5):
    m = x.mean(dim=axis, keepdim=True)
    v = x.var(dim=axis, keepdim=True, unbiased=False)
    return (x - m) / torch.sqrt(v + eps)
def _scatter_add(tgt, idx, src, axis=0):
    return tgt.clone().index_add_(axis, idx, src)
def _segment_sum(src, seg, n):
    out = torch.zeros((n,) + src.shape[1:], dtype=src.dtype)
    return out.index_add_(0, seg, src)
def _pad(x, pw):
    flat = tuple(v for pair in reversed(pw) for v in pair)
    return torch.nn.functional.pad(x, flat)

kernel_name = 'sequential_preLN__compressed_kv_cla__mixer_token_mlp__decode'

def setup_inputs():

    _w = (lambda a: (lambda t: t.to(torch.bfloat16) if t.is_floating_point() else t)(torch.as_tensor(a)))
    def _A_setup():
        B, H, Sq, Sk, D, M = 1, 32, 1, 4096, 128, 640
        Dc = 4 * D
        return {
            "x": _w((lambda *s: torch.randn(*s, dtype=torch.bfloat16) * 0.05)(B, Sq, M)),
            "c_kv": _w((lambda *s: torch.randn(*s, dtype=torch.bfloat16) * 0.8)(B, Sk, Dc)),
            "w_q": _w((lambda *s: torch.randn(*s, dtype=torch.bfloat16) * 0.8)(M, H, D) * (M ** -0.5)),
            "w_uk": _w((lambda *s: torch.randn(*s, dtype=torch.bfloat16) * 0.8)(Dc, H, D) * (Dc ** -0.5)),
            "w_uv": _w((lambda *s: torch.randn(*s, dtype=torch.bfloat16) * 0.8)(Dc, H, D) * (Dc ** -0.5)),
            "w_o": _w((lambda *s: torch.randn(*s, dtype=torch.bfloat16) * 0.8)(H, D, M) * ((H * D) ** -0.5)),
        }
    _A_in = _A_setup()

    def _B_setup():
        B, S, D, F = 1, 1, 640, 1728
        return {
            "x": _w((lambda *s: torch.randn(*s, dtype=torch.bfloat16) * 0.05)(B, S, D)),
            "w1": _w((lambda *s: torch.randn(*s, dtype=torch.bfloat16) * 0.2)(S, F) * (S ** -0.5)),
            "b1": _w((lambda *s: torch.randn(*s, dtype=torch.bfloat16) * 0.2)(F) * 0.02),
            "w2": _w((lambda *s: torch.randn(*s, dtype=torch.bfloat16) * 0.2)(F, S) * (F ** -0.5)),
            "b2": _w((lambda *s: torch.randn(*s, dtype=torch.bfloat16) * 0.2)(S) * 0.02),
        }
    _B_in = _B_setup()

    return {
        "A_x": _A_in["x"],
        "A_c_kv": _A_in["c_kv"],
        "A_w_q": _A_in["w_q"],
        "A_w_uk": _A_in["w_uk"],
        "A_w_uv": _A_in["w_uv"],
        "A_w_o": _A_in["w_o"],
        "B_x": _B_in["x"],
        "B_w1": _B_in["w1"],
        "B_b1": _B_in["b1"],
        "B_w2": _B_in["w2"],
        "B_b2": _B_in["b2"],
    }

def reference(A_x, A_c_kv, A_w_q, A_w_uk, A_w_uv, A_w_o, B_x, B_w1, B_b1, B_w2, B_b2):
    def _A_ref(x, c_kv, w_q, w_uk, w_uv, w_o):
        B, Sq, M = x.shape[0], x.shape[1], x.shape[2]
        Sk = c_kv.shape[1]
        H, D = w_q.shape[1], w_q.shape[2]
        q = torch.einsum("bqm,mhd->bhqd", x, w_q)
        k = torch.einsum("bkc,chd->bhkd", c_kv, w_uk)
        v = torch.einsum("bkc,chd->bhkd", c_kv, w_uv)
        scores = torch.einsum("bhqd,bhkd->bhqk", q, k) * (D ** -0.5)
        off = Sk - Sq
        qi = torch.arange(Sq)[:, None]
        kj = torch.arange(Sk)[None, :]
        cmask = kj <= (qi + off)
        scores = torch.where(cmask[None, None], scores, -1e9)
        p = _softmax(scores, axis=-1)
        ctx = torch.einsum("bhqk,bhkd->bhqd", p, v)
        return torch.einsum("bhqd,hdm->bqm", ctx, w_o)

    def _B_ref(x, w1, b1, w2, b2):
        B, S, D = x.shape
        h = _layernorm(x, axis=-1)
        u = torch.einsum("bsd,sf->bdf", h, w1) + b1
        u = _gelu(u)
        y = torch.einsum("bdf,fs->bds", u, w2) + b2
        return (lambda x, *d: x.permute(*d))(y, 0, 2, 1)

    x = A_x
    h = x + _A_ref(_layernorm(x, axis=-1), A_c_kv, A_w_q, A_w_uk, A_w_uv, A_w_o)
    h2 = h + _B_ref(_layernorm(h, axis=-1), B_w1, B_b1, B_w2, B_b2)
    return h2
```

```asm
; @launch grid=(256,1,1) block=(256,1,1) lds=156672
.amdgcn_target "amdgcn-amd-amdhsa--gfx950"
.text
.globl sequential_preLN__compressed_kv_cla__mixer_token_mlp__decode_kernel
.p2align 8
.type sequential_preLN__compressed_kv_cla__mixer_token_mlp__decode_kernel,@function
sequential_preLN__compressed_kv_cla__mixer_token_mlp__decode_kernel:
    s_load_dwordx16 s[4:19], s[0:1], 0
    s_load_dwordx8 s[20:27], s[0:1], 64
    s_load_dwordx4 s[28:31], s[0:1], 96
    s_getpc_b64 s[52:53]
L_pc:
    s_sub_u32 s52, s52, L_pc-sequential_preLN__compressed_kv_cla__mixer_token_mlp__decode_kernel
    s_subb_u32 s53, s53, 0
    v_lshlrev_b32 v254, 7, v0
    s_mov_b32 s54, CODE_BYTES
    s_mov_b32 s55, 0x00020000
    buffer_load_dword v251, v254, s[52:55], 0 offen
    s_cmp_ge_u32 s2, 256
    s_cbranch_scc1 L_end
    v_and_b32 v1, 63, v0
    v_lshrrev_b32 v2, 6, v0
    v_and_b32 v3, 15, v0
    v_bfe_u32 v4, v0, 4, 2
    v_readfirstlane_b32 s57, v2
    s_and_b32 s61, s2, 7
    s_bfe_u32 s62, s2, 0x40003
    s_lshl_b32 s58, s61, 4
    s_add_u32 s58, s58, s62
    s_lshr_b32 s59, s58, 2
    s_and_b32 s60, s58, 3
    v_mov_b32 v18, 0
    v_mov_b32 v240, 0
    v_mov_b32 v241, 0
    v_mov_b32 v242, 0
    v_mov_b32 v243, 0
    v_mov_b32 v244, 0
    s_lshr_b32 s72, s2, 6
    s_and_b32 s73, s2, 7
    s_lshl_b32 s73, s73, 2
    s_add_u32 s72, s72, s73
    s_bfe_u32 s73, s2, 0x30003
    v_lshlrev_b32 v5, 4, v1
    v_lshlrev_b32 v17, 2, v1
    v_lshrrev_b32 v6, 4, v0
    v_mul_u32_u24 v13, 5, v6
    s_mul_i32 s62, s73, 160
    v_lshlrev_b32 v7, 1, v13
    v_add_u32 v7, s62, v7
    v_and_b32 v14, 2, v7
    v_lshlrev_b32 v14, 3, v14
    v_and_b32 v7, -4, v7
    v_lshlrev_b32 v8, 4, v3
    v_lshl_add_u32 v8, v13, 13, v8
    v_mov_b32 v255, v14
    s_mul_i32 s61, s73, 655360
    s_lshl_b32 s62, s72, 8
    s_add_u32 s61, s61, s62
    v_xor_b32 v9, v3, v4
    v_lshlrev_b32 v9, 4, v9
    v_lshl_add_u32 v9, v4, 13, v9
    v_xor_b32 v10, 64, v9
    v_xor_b32 v11, 128, v9
    v_xor_b32 v12, 192, v9
    s_mov_b32 s34, 5242880
    s_mov_b32 s35, 0x00020000
    s_mov_b32 s38, 1280
    s_mov_b32 s39, 0x00020000
    s_mov_b32 s42, 5242880
    s_mov_b32 s43, 0x00020000
    s_waitcnt lgkmcnt(0)
    s_mov_b32 s36, s4
    s_mov_b32 s37, s5
    s_mov_b32 s32, s30
    s_mov_b32 s33, s31
    s_mov_b32 s40, s8
    s_mov_b32 s41, s9
    buffer_load_dwordx4 v[32:35], v5, s[36:39], 0 offen
    buffer_load_dword v36, v17, s[36:39], 0 offen offset:1024
    buffer_load_dword v250, v18, s[32:35], 0 offen
    buffer_load_dwordx3 v[52:54], v7, s[36:39], 0 offen
    buffer_load_dwordx4 v[60:63], v8, s[40:43], s61 offen nt
    s_add_u32 s61, s61, 8192
    buffer_load_dwordx4 v[64:67], v8, s[40:43], s61 offen nt
    s_add_u32 s61, s61, 8192
    buffer_load_dwordx4 v[68:71], v8, s[40:43], s61 offen nt
    s_add_u32 s61, s61, 8192
    buffer_load_dwordx4 v[72:75], v8, s[40:43], s61 offen nt
    s_add_u32 s61, s61, 8192
    buffer_load_dwordx4 v[76:79], v8, s[40:43], s61 offen nt
    s_bitcmp1_b32 s2, 7
    s_cbranch_scc1 L_nouk
    s_mov_b32 s44, s10
    s_mov_b32 s45, s11
    s_mov_b32 s46, 4194304
    s_mov_b32 s47, 0x00020000
    s_lshl_b32 s66, s60, 20
    s_lshl_b32 s63, s59, 8
    s_add_u32 s66, s66, s63
    s_lshl_b32 s63, s57, 18
    s_add_u32 s66, s66, s63
    s_lshl_b32 s67, s57, 13
    s_mov_b32 m0, s67
    s_add_u32 s67, s67, 1024
    buffer_load_dwordx4 v9, s[44:47], s66 offen nt lds
    s_add_u32 s66, s66, 32768
    s_mov_b32 m0, s67
    s_add_u32 s67, s67, 1024
    buffer_load_dwordx4 v10, s[44:47], s66 offen nt lds
    s_add_u32 s66, s66, 32768
    s_mov_b32 m0, s67
    s_add_u32 s67, s67, 1024
    buffer_load_dwordx4 v11, s[44:47], s66 offen nt lds
    s_add_u32 s66, s66, 32768
    s_mov_b32 m0, s67
    s_add_u32 s67, s67, 1024
    buffer_load_dwordx4 v12, s[44:47], s66 offen nt lds
    s_add_u32 s66, s66, 32768
    s_mov_b32 m0, s67
    s_add_u32 s67, s67, 1024
    buffer_load_dwordx4 v9, s[44:47], s66 offen nt lds
    s_add_u32 s66, s66, 32768
    s_mov_b32 m0, s67
    s_add_u32 s67, s67, 1024
    buffer_load_dwordx4 v10, s[44:47], s66 offen nt lds
    s_add_u32 s66, s66, 32768
    s_mov_b32 m0, s67
    s_add_u32 s67, s67, 1024
    buffer_load_dwordx4 v11, s[44:47], s66 offen nt lds
    s_add_u32 s66, s66, 32768
    s_mov_b32 m0, s67
    s_add_u32 s67, s67, 1024
    buffer_load_dwordx4 v12, s[44:47], s66 offen nt lds
    v_and_b32 v253, 31, v1
    v_lshlrev_b32 v253, 7, v253
    s_lshl_b32 s62, s59, 12
    s_add_u32 s62, s62, 4096
    buffer_load_dword v252, v253, s[32:35], s62 offen nt
    s_branch L_s1c
L_nouk:
    s_mov_b32 s44, s6
    s_mov_b32 s45, s7
    s_mov_b32 s46, 4194304
    s_mov_b32 s47, 0x00020000
    v_lshlrev_b32 v9, 4, v1
    s_lshl_b32 s68, s59, 17
    s_lshl_b32 s63, s57, 15
    s_add_u32 s68, s68, s63
    s_mul_i32 s69, s57, 33792
L_s1c:
    v_lshlrev_b32 v241, 9, v6
    v_lshl_add_u32 v241, v3, 4, v241
    v_add_u32 v241, 148480, v241
    v_and_b32 v14, 31, v1
    v_lshrrev_b32 v242, 3, v14
    s_lshl_b32 s62, s57, 2
    v_add_u32 v242, s62, v242
    v_lshlrev_b32 v242, 4, v242
    v_bfe_u32 v16, v1, 2, 1
    v_lshl_add_u32 v242, v16, 8, v242
    v_and_b32 v16, 3, v1
    v_lshl_add_u32 v242, v16, 2, v242
    v_lshrrev_b32 v16, 5, v1
    v_lshl_add_u32 v242, v16, 12, v242
    v_add_u32 v242, 148480, v242
    s_lshl_b32 s70, s72, 12
    s_lshl_b32 s63, s57, 10
    s_add_u32 s70, s70, s63
    s_lshl_b32 s63, s73, 4
    s_add_u32 s70, s70, s63
    s_add_u32 s70, s70, 4096
    s_add_u32 s71, s70, 315392
    v_lshrrev_b32 v237, 3, v14
    v_lshlrev_b32 v237, 7, v237
    v_bfe_u32 v16, v14, 2, 1
    v_lshl_add_u32 v237, v16, 9, v237
    v_bfe_u32 v16, v14, 1, 1
    v_lshl_add_u32 v237, v16, 3, v237
    s_bitcmp1_b32 s2, 7
    s_cbranch_scc1 L_s1y
    s_waitcnt vmcnt(15)
    v_readfirstlane_b32 s56, v250
    s_nop 0
    s_add_u32 s56, s56, 1
    s_mov_b32 s63, 0xffff0000
    v_lshlrev_b32 v100, 16, v32
    v_and_b32 v101, s63, v32
    v_lshlrev_b32 v102, 16, v33
    v_and_b32 v103, s63, v33
    v_lshlrev_b32 v104, 16, v34
    v_and_b32 v105, s63, v34
    v_lshlrev_b32 v106, 16, v35
    v_and_b32 v107, s63, v35
    v_lshlrev_b32 v108, 16, v36
    v_and_b32 v109, s63, v36
    v_readfirstlane_b32 s64, v100
    s_nop 1
    v_subrev_f32 v100, s64, v100
    v_subrev_f32 v101, s64, v101
    v_subrev_f32 v102, s64, v102
    v_subrev_f32 v103, s64, v103
    v_subrev_f32 v104, s64, v104
    v_subrev_f32 v105, s64, v105
    v_subrev_f32 v106, s64, v106
    v_subrev_f32 v107, s64, v107
    v_subrev_f32 v108, s64, v108
    v_subrev_f32 v109, s64, v109
    s_mov_b32 s3, s64
    v_add_f32 v110, v100, v101
    v_mul_f32 v112, v100, v100
    v_fmac_f32 v112, v101, v101
    v_add_f32 v110, v110, v102
    v_fmac_f32 v112, v102, v102
    v_add_f32 v110, v110, v103
    v_fmac_f32 v112, v103, v103
    v_add_f32 v110, v110, v104
    v_fmac_f32 v112, v104, v104
    v_add_f32 v110, v110, v105
    v_fmac_f32 v112, v105, v105
    v_add_f32 v110, v110, v106
    v_fmac_f32 v112, v106, v106
    v_add_f32 v110, v110, v107
    v_fmac_f32 v112, v107, v107
    v_add_f32 v110, v110, v108
    v_fmac_f32 v112, v108, v108
    v_add_f32 v110, v110, v109
    v_fmac_f32 v112, v109, v109
    s_nop 0
    v_add_f32_dpp v110, v110, v110 quad_perm:[1,0,3,2] row_mask:0xf bank_mask:0xf
    v_add_f32_dpp v112, v112, v112 quad_perm:[1,0,3,2] row_mask:0xf bank_mask:0xf
    s_nop 0
    v_add_f32_dpp v110, v110, v110 quad_perm:[2,3,0,1] row_mask:0xf bank_mask:0xf
    v_add_f32_dpp v112, v112, v112 quad_perm:[2,3,0,1] row_mask:0xf bank_mask:0xf
    s_nop 0
    v_add_f32_dpp v110, v110, v110 row_half_mirror row_mask:0xf bank_mask:0xf
    v_add_f32_dpp v112, v112, v112 row_half_mirror row_mask:0xf bank_mask:0xf
    s_nop 0
    v_add_f32_dpp v110, v110, v110 row_mirror row_mask:0xf bank_mask:0xf
    v_add_f32_dpp v112, v112, v112 row_mirror row_mask:0xf bank_mask:0xf
    v_mov_b32 v111, v110
    v_mov_b32 v113, v112
    s_nop 0
    v_permlane16_swap_b32 v110, v111
    v_permlane16_swap_b32 v112, v113
    v_add_f32 v110, v110, v111
    v_add_f32 v112, v112, v113
    v_mov_b32 v111, v110
    v_mov_b32 v113, v112
    s_nop 0
    v_permlane32_swap_b32 v110, v111
    v_permlane32_swap_b32 v112, v113
    v_add_f32 v110, v110, v111
    v_add_f32 v112, v112, v113
    s_mov_b32 s65, 0x3acccccd
    v_mul_f32 v110, s65, v110
    v_mul_f32 v112, s65, v112
    v_fma_f32 v112, -v110, v110, v112
    v_add_f32 v112, 0x3727c5ac, v112
    v_rsq_f32 v113, v112
    v_add_f32 v110, s64, v110
    s_waitcnt vmcnt(14)
    v_alignbit_b32 v55, v53, v52, v255
    v_alignbit_b32 v56, v54, v53, v255
    v_lshrrev_b32 v57, v255, v54
    v_lshlrev_b32 v40, 16, v55
    v_and_b32 v42, s63, v55
    v_lshlrev_b32 v44, 16, v56
    v_and_b32 v46, s63, v56
    v_lshlrev_b32 v48, 16, v57
    v_sub_f32 v40, v40, v110
    v_mul_f32 v40, v40, v113
    v_sub_f32 v42, v42, v110
    v_mul_f32 v42, v42, v113
    v_sub_f32 v44, v44, v110
    v_mul_f32 v44, v44, v113
    v_sub_f32 v46, v46, v110
    v_mul_f32 v46, v46, v113
    v_sub_f32 v48, v48, v110
    v_mul_f32 v48, v48, v113
    v_mov_b32 v100, 0
    v_mov_b32 v101, 0
    v_mov_b32 v102, 0
    v_mov_b32 v103, 0
    v_mov_b32 v104, 0
    v_mov_b32 v105, 0
    v_mov_b32 v106, 0
    v_mov_b32 v107, 0
    s_waitcnt vmcnt(13)
    v_lshlrev_b32 v108, 16, v60
    v_and_b32 v109, s63, v60
    v_pk_fma_f32 v[100:101], v[108:109], v[40:41], v[100:101] op_sel_hi:[1,0,1]
    v_lshlrev_b32 v110, 16, v61
    v_and_b32 v111, s63, v61
    v_pk_fma_f32 v[102:103], v[110:111], v[40:41], v[102:103] op_sel_hi:[1,0,1]
    v_lshlrev_b32 v108, 16, v62
    v_and_b32 v109, s63, v62
    v_pk_fma_f32 v[104:105], v[108:109], v[40:41], v[104:105] op_sel_hi:[1,0,1]
    v_lshlrev_b32 v110, 16, v63
    v_and_b32 v111, s63, v63
    v_pk_fma_f32 v[106:107], v[110:111], v[40:41], v[106:107] op_sel_hi:[1,0,1]
    s_waitcnt vmcnt(12)
    v_lshlrev_b32 v108, 16, v64
    v_and_b32 v109, s63, v64
    v_pk_fma_f32 v[100:101], v[108:109], v[42:43], v[100:101] op_sel_hi:[1,0,1]
    v_lshlrev_b32 v110, 16, v65
    v_and_b32 v111, s63, v65
    v_pk_fma_f32 v[102:103], v[110:111], v[42:43], v[102:103] op_sel_hi:[1,0,1]
    v_lshlrev_b32 v108, 16, v66
    v_and_b32 v109, s63, v66
    v_pk_fma_f32 v[104:105], v[108:109], v[42:43], v[104:105] op_sel_hi:[1,0,1]
    v_lshlrev_b32 v110, 16, v67
    v_and_b32 v111, s63, v67
    v_pk_fma_f32 v[106:107], v[110:111], v[42:43], v[106:107] op_sel_hi:[1,0,1]
    s_waitcnt vmcnt(11)
    v_lshlrev_b32 v108, 16, v68
    v_and_b32 v109, s63, v68
    v_pk_fma_f32 v[100:101], v[108:109], v[44:45], v[100:101] op_sel_hi:[1,0,1]
    v_lshlrev_b32 v110, 16, v69
    v_and_b32 v111, s63, v69
    v_pk_fma_f32 v[102:103], v[110:111], v[44:45], v[102:103] op_sel_hi:[1,0,1]
    v_lshlrev_b32 v108, 16, v70
    v_and_b32 v109, s63, v70
    v_pk_fma_f32 v[104:105], v[108:109], v[44:45], v[104:105] op_sel_hi:[1,0,1]
    v_lshlrev_b32 v110, 16, v71
    v_and_b32 v111, s63, v71
    v_pk_fma_f32 v[106:107], v[110:111], v[44:45], v[106:107] op_sel_hi:[1,0,1]
    s_waitcnt vmcnt(10)
    v_lshlrev_b32 v108, 16, v72
    v_and_b32 v109, s63, v72
    v_pk_fma_f32 v[100:101], v[108:109], v[46:47], v[100:101] op_sel_hi:[1,0,1]
    v_lshlrev_b32 v110, 16, v73
    v_and_b32 v111, s63, v73
    v_pk_fma_f32 v[102:103], v[110:111], v[46:47], v[102:103] op_sel_hi:[1,0,1]
    v_lshlrev_b32 v108, 16, v74
    v_and_b32 v109, s63, v74
    v_pk_fma_f32 v[104:105], v[108:109], v[46:47], v[104:105] op_sel_hi:[1,0,1]
    v_lshlrev_b32 v110, 16, v75
    v_and_b32 v111, s63, v75
    v_pk_fma_f32 v[106:107], v[110:111], v[46:47], v[106:107] op_sel_hi:[1,0,1]
    s_waitcnt vmcnt(9)
    v_lshlrev_b32 v108, 16, v76
    v_and_b32 v109, s63, v76
    v_pk_fma_f32 v[100:101], v[108:109], v[48:49], v[100:101] op_sel_hi:[1,0,1]
    v_lshlrev_b32 v110, 16, v77
    v_and_b32 v111, s63, v77
    v_pk_fma_f32 v[102:103], v[110:111], v[48:49], v[102:103] op_sel_hi:[1,0,1]
    v_lshlrev_b32 v108, 16, v78
    v_and_b32 v109, s63, v78
    v_pk_fma_f32 v[104:105], v[108:109], v[48:49], v[104:105] op_sel_hi:[1,0,1]
    v_lshlrev_b32 v110, 16, v79
    v_and_b32 v111, s63, v79
    v_pk_fma_f32 v[106:107], v[110:111], v[48:49], v[106:107] op_sel_hi:[1,0,1]
    s_branch L_s1r
L_s1y:
    s_waitcnt vmcnt(6)
    v_readfirstlane_b32 s56, v250
    s_nop 0
    s_add_u32 s56, s56, 1
    s_mov_b32 s63, 0xffff0000
    v_lshlrev_b32 v100, 16, v32
    v_and_b32 v101, s63, v32
    v_lshlrev_b32 v102, 16, v33
    v_and_b32 v103, s63, v33
    v_lshlrev_b32 v104, 16, v34
    v_and_b32 v105, s63, v34
    v_lshlrev_b32 v106, 16, v35
    v_and_b32 v107, s63, v35
    v_lshlrev_b32 v108, 16, v36
    v_and_b32 v109, s63, v36
    v_readfirstlane_b32 s64, v100
    s_nop 1
    v_subrev_f32 v100, s64, v100
    v_subrev_f32 v101, s64, v101
    v_subrev_f32 v102, s64, v102
    v_subrev_f32 v103, s64, v103
    v_subrev_f32 v104, s64, v104
    v_subrev_f32 v105, s64, v105
    v_subrev_f32 v106, s64, v106
    v_subrev_f32 v107, s64, v107
    v_subrev_f32 v108, s64, v108
    v_subrev_f32 v109, s64, v109
    s_mov_b32 s3, s64
    v_add_f32 v110, v100, v101
    v_mul_f32 v112, v100, v100
    v_fmac_f32 v112, v101, v101
    v_add_f32 v110, v110, v102
    v_fmac_f32 v112, v102, v102
    v_add_f32 v110, v110, v103
    v_fmac_f32 v112, v103, v103
    v_add_f32 v110, v110, v104
    v_fmac_f32 v112, v104, v104
    v_add_f32 v110, v110, v105
    v_fmac_f32 v112, v105, v105
    v_add_f32 v110, v110, v106
    v_fmac_f32 v112, v106, v106
    v_add_f32 v110, v110, v107
    v_fmac_f32 v112, v107, v107
    v_add_f32 v110, v110, v108
    v_fmac_f32 v112, v108, v108
    v_add_f32 v110, v110, v109
    v_fmac_f32 v112, v109, v109
    s_nop 0
    v_add_f32_dpp v110, v110, v110 quad_perm:[1,0,3,2] row_mask:0xf bank_mask:0xf
    v_add_f32_dpp v112, v112, v112 quad_perm:[1,0,3,2] row_mask:0xf bank_mask:0xf
    s_nop 0
    v_add_f32_dpp v110, v110, v110 quad_perm:[2,3,0,1] row_mask:0xf bank_mask:0xf
    v_add_f32_dpp v112, v112, v112 quad_perm:[2,3,0,1] row_mask:0xf bank_mask:0xf
    s_nop 0
    v_add_f32_dpp v110, v110, v110 row_half_mirror row_mask:0xf bank_mask:0xf
    v_add_f32_dpp v112, v112, v112 row_half_mirror row_mask:0xf bank_mask:0xf
    s_nop 0
    v_add_f32_dpp v110, v110, v110 row_mirror row_mask:0xf bank_mask:0xf
    v_add_f32_dpp v112, v112, v112 row_mirror row_mask:0xf bank_mask:0xf
    v_mov_b32 v111, v110
    v_mov_b32 v113, v112
    s_nop 0
    v_permlane16_swap_b32 v110, v111
    v_permlane16_swap_b32 v112, v113
    v_add_f32 v110, v110, v111
    v_add_f32 v112, v112, v113
    v_mov_b32 v111, v110
    v_mov_b32 v113, v112
    s_nop 0
    v_permlane32_swap_b32 v110, v111
    v_permlane32_swap_b32 v112, v113
    v_add_f32 v110, v110, v111
    v_add_f32 v112, v112, v113
    s_mov_b32 s65, 0x3acccccd
    v_mul_f32 v110, s65, v110
    v_mul_f32 v112, s65, v112
    v_fma_f32 v112, -v110, v110, v112
    v_add_f32 v112, 0x3727c5ac, v112
    v_rsq_f32 v113, v112
    v_add_f32 v110, s64, v110
    s_waitcnt vmcnt(5)
    v_alignbit_b32 v55, v53, v52, v255
    v_alignbit_b32 v56, v54, v53, v255
    v_lshrrev_b32 v57, v255, v54
    v_lshlrev_b32 v40, 16, v55
    v_and_b32 v42, s63, v55
    v_lshlrev_b32 v44, 16, v56
    v_and_b32 v46, s63, v56
    v_lshlrev_b32 v48, 16, v57
    v_sub_f32 v40, v40, v110
    v_mul_f32 v40, v40, v113
    v_sub_f32 v42, v42, v110
    v_mul_f32 v42, v42, v113
    v_sub_f32 v44, v44, v110
    v_mul_f32 v44, v44, v113
    v_sub_f32 v46, v46, v110
    v_mul_f32 v46, v46, v113
    v_sub_f32 v48, v48, v110
    v_mul_f32 v48, v48, v113
    v_mov_b32 v100, 0
    v_mov_b32 v101, 0
    v_mov_b32 v102, 0
    v_mov_b32 v103, 0
    v_mov_b32 v104, 0
    v_mov_b32 v105, 0
    v_mov_b32 v106, 0
    v_mov_b32 v107, 0
    s_waitcnt vmcnt(4)
    v_lshlrev_b32 v108, 16, v60
    v_and_b32 v109, s63, v60
    v_pk_fma_f32 v[100:101], v[108:109], v[40:41], v[100:101] op_sel_hi:[1,0,1]
    v_lshlrev_b32 v110, 16, v61
    v_and_b32 v111, s63, v61
    v_pk_fma_f32 v[102:103], v[110:111], v[40:41], v[102:103] op_sel_hi:[1,0,1]
    v_lshlrev_b32 v108, 16, v62
    v_and_b32 v109, s63, v62
    v_pk_fma_f32 v[104:105], v[108:109], v[40:41], v[104:105] op_sel_hi:[1,0,1]
    v_lshlrev_b32 v110, 16, v63
    v_and_b32 v111, s63, v63
    v_pk_fma_f32 v[106:107], v[110:111], v[40:41], v[106:107] op_sel_hi:[1,0,1]
    s_waitcnt vmcnt(3)
    v_lshlrev_b32 v108, 16, v64
    v_and_b32 v109, s63, v64
    v_pk_fma_f32 v[100:101], v[108:109], v[42:43], v[100:101] op_sel_hi:[1,0,1]
    v_lshlrev_b32 v110, 16, v65
    v_and_b32 v111, s63, v65
    v_pk_fma_f32 v[102:103], v[110:111], v[42:43], v[102:103] op_sel_hi:[1,0,1]
    v_lshlrev_b32 v108, 16, v66
    v_and_b32 v109, s63, v66
    v_pk_fma_f32 v[104:105], v[108:109], v[42:43], v[104:105] op_sel_hi:[1,0,1]
    v_lshlrev_b32 v110, 16, v67
    v_and_b32 v111, s63, v67
    v_pk_fma_f32 v[106:107], v[110:111], v[42:43], v[106:107] op_sel_hi:[1,0,1]
    s_waitcnt vmcnt(2)
    v_lshlrev_b32 v108, 16, v68
    v_and_b32 v109, s63, v68
    v_pk_fma_f32 v[100:101], v[108:109], v[44:45], v[100:101] op_sel_hi:[1,0,1]
    v_lshlrev_b32 v110, 16, v69
    v_and_b32 v111, s63, v69
    v_pk_fma_f32 v[102:103], v[110:111], v[44:45], v[102:103] op_sel_hi:[1,0,1]
    v_lshlrev_b32 v108, 16, v70
    v_and_b32 v109, s63, v70
    v_pk_fma_f32 v[104:105], v[108:109], v[44:45], v[104:105] op_sel_hi:[1,0,1]
    v_lshlrev_b32 v110, 16, v71
    v_and_b32 v111, s63, v71
    v_pk_fma_f32 v[106:107], v[110:111], v[44:45], v[106:107] op_sel_hi:[1,0,1]
    s_waitcnt vmcnt(1)
    v_lshlrev_b32 v108, 16, v72
    v_and_b32 v109, s63, v72
    v_pk_fma_f32 v[100:101], v[108:109], v[46:47], v[100:101] op_sel_hi:[1,0,1]
    v_lshlrev_b32 v110, 16, v73
    v_and_b32 v111, s63, v73
    v_pk_fma_f32 v[102:103], v[110:111], v[46:47], v[102:103] op_sel_hi:[1,0,1]
    v_lshlrev_b32 v108, 16, v74
    v_and_b32 v109, s63, v74
    v_pk_fma_f32 v[104:105], v[108:109], v[46:47], v[104:105] op_sel_hi:[1,0,1]
    v_lshlrev_b32 v110, 16, v75
    v_and_b32 v111, s63, v75
    v_pk_fma_f32 v[106:107], v[110:111], v[46:47], v[106:107] op_sel_hi:[1,0,1]
    s_waitcnt vmcnt(0)
    v_lshlrev_b32 v108, 16, v76
    v_and_b32 v109, s63, v76
    v_pk_fma_f32 v[100:101], v[108:109], v[48:49], v[100:101] op_sel_hi:[1,0,1]
    v_lshlrev_b32 v110, 16, v77
    v_and_b32 v111, s63, v77
    v_pk_fma_f32 v[102:103], v[110:111], v[48:49], v[102:103] op_sel_hi:[1,0,1]
    v_lshlrev_b32 v108, 16, v78
    v_and_b32 v109, s63, v78
    v_pk_fma_f32 v[104:105], v[108:109], v[48:49], v[104:105] op_sel_hi:[1,0,1]
    v_lshlrev_b32 v110, 16, v79
    v_and_b32 v111, s63, v79
    v_pk_fma_f32 v[106:107], v[110:111], v[48:49], v[106:107] op_sel_hi:[1,0,1]
L_s1r:
    ds_write_b128 v241, v[100:103]
    ds_write_b128 v241, v[104:107] offset:256
    s_waitcnt lgkmcnt(0)
    s_barrier
    ds_read2st64_b32 v[100:101], v242 offset0:0 offset1:2
    ds_read2st64_b32 v[102:103], v242 offset0:4 offset1:6
    ds_read2st64_b32 v[104:105], v242 offset0:8 offset1:10
    ds_read2st64_b32 v[106:107], v242 offset0:12 offset1:14
    s_waitcnt lgkmcnt(0)
    v_add_f32 v100, v100, v101
    v_add_f32 v102, v102, v103
    v_add_f32 v104, v104, v105
    v_add_f32 v106, v106, v107
    v_add_f32 v100, v100, v102
    v_add_f32 v104, v104, v106
    v_add_f32 v100, v100, v104
    v_mov_b32 v101, v100
    s_nop 1
    v_permlane32_swap_b32 v100, v101
    v_add_f32 v100, v100, v101
    s_nop 1
    v_mov_b32_dpp v101, v100 row_shl:1 row_mask:0xf bank_mask:0xf
    v_cvt_pk_bf16_f32 v238, v100, v101
    v_mov_b32 v239, s56
    s_mov_b32 exec_lo, 0x55555555
    s_mov_b32 exec_hi, 0
    buffer_store_dwordx2 v[238:239], v237, s[32:35], s70 offen
    s_bitcmp1_b32 s2, 7
    s_cbranch_scc0 L_Xgo
    buffer_store_dwordx2 v[238:239], v237, s[32:35], s71 offen sc1
    s_mov_b64 exec, -1
    s_branch L_Y
L_Xgo:
    s_mov_b64 exec, -1
    s_mov_b32 s48, s12
    s_mov_b32 s49, s13
    s_mov_b32 s50, 4194304
    s_mov_b32 s51, 0x00020000
    v_and_b32 v17, 7, v3
    v_lshlrev_b32 v17, 4, v17
    v_lshl_add_u32 v17, v4, 7, v17
    s_lshl_b32 s63, s59, 12
    s_add_u32 s63, s63, 4096
    s_add_u32 s64, s63, 315392
    s_waitcnt vmcnt(3)
    buffer_load_dwordx4 v[148:151], v17, s[32:35], s63 offen offset:0 nt
    buffer_load_dwordx4 v[152:155], v17, s[32:35], s63 offen offset:512 nt
    buffer_load_dwordx4 v[156:159], v17, s[32:35], s63 offen offset:1024 nt
    buffer_load_dwordx4 v[160:163], v17, s[32:35], s63 offen offset:1536 nt
    buffer_load_dwordx4 v[164:167], v17, s[32:35], s63 offen offset:2048 nt
    buffer_load_dwordx4 v[168:171], v17, s[32:35], s63 offen offset:2560 nt
    buffer_load_dwordx4 v[172:175], v17, s[32:35], s63 offen offset:3072 nt
    buffer_load_dwordx4 v[176:179], v17, s[32:35], s63 offen offset:3584 nt
    s_lshl_b32 s62, s57, 5
    v_add_u32 v13, s62, v3
    v_lshlrev_b32 v13, 8, v13
    v_xor_b32 v14, v3, v4
    v_lshl_add_u32 v13, v14, 4, v13
    v_xor_b32 v14, 64, v13
    v_xor_b32 v15, 128, v13
    v_xor_b32 v16, 192, v13
    s_waitcnt vmcnt(9)
    ds_read_b128 v[116:119], v13 offset:0
    ds_read_b128 v[120:123], v14 offset:0
    ds_read_b128 v[124:127], v15 offset:0
    ds_read_b128 v[128:131], v16 offset:0
    ds_read_b128 v[132:135], v13 offset:4096
    ds_read_b128 v[136:139], v14 offset:4096
    ds_read_b128 v[140:143], v15 offset:4096
    ds_read_b128 v[144:147], v16 offset:4096
    v_mov_b32 v13, v17
    s_waitcnt vmcnt(0)
    v_xor_b32 v14, s56, v149
    v_bitop3_b32 v14, v151, s56, v14 bitop3:0xbe
    v_bitop3_b32 v14, v153, s56, v14 bitop3:0xbe
    v_bitop3_b32 v14, v155, s56, v14 bitop3:0xbe
    v_bitop3_b32 v14, v157, s56, v14 bitop3:0xbe
    v_bitop3_b32 v14, v159, s56, v14 bitop3:0xbe
    v_bitop3_b32 v14, v161, s56, v14 bitop3:0xbe
    v_bitop3_b32 v14, v163, s56, v14 bitop3:0xbe
    v_bitop3_b32 v14, v165, s56, v14 bitop3:0xbe
    v_bitop3_b32 v14, v167, s56, v14 bitop3:0xbe
    v_bitop3_b32 v14, v169, s56, v14 bitop3:0xbe
    v_bitop3_b32 v14, v171, s56, v14 bitop3:0xbe
    v_bitop3_b32 v14, v173, s56, v14 bitop3:0xbe
    v_bitop3_b32 v14, v175, s56, v14 bitop3:0xbe
    v_bitop3_b32 v14, v177, s56, v14 bitop3:0xbe
    v_bitop3_b32 v14, v179, s56, v14 bitop3:0xbe
    s_mov_b32 s61, 0
    v_cmp_ne_u32 vcc, 0, v14
    s_cbranch_vccz L_p1_x
    s_and_b64 exec, exec, vcc
    s_mov_b32 s61, 0
L_p1:
    s_and_b32 s75, s61, 31
    s_cmp_eq_u32 s75, 31
    s_cselect_b32 s62, s64, s63
    s_cmp_eq_u32 s61, 31
    s_cbranch_scc0 L_p1n
    s_mov_b64 s[98:99], exec
    s_mov_b32 exec_lo, 0x55555555
    s_mov_b32 exec_hi, 0
    buffer_store_dwordx2 v[238:239], v237, s[32:35], s71 offen sc1
    s_mov_b64 exec, s[98:99]
L_p1n:
    s_cmp_eq_u32 s75, 31
    s_cbranch_scc1 L_p1_b
    buffer_load_dwordx4 v[148:151], v13, s[32:35], s62 offen offset:0 nt
    buffer_load_dwordx4 v[152:155], v13, s[32:35], s62 offen offset:512 nt
    buffer_load_dwordx4 v[156:159], v13, s[32:35], s62 offen offset:1024 nt
    buffer_load_dwordx4 v[160:163], v13, s[32:35], s62 offen offset:1536 nt
    buffer_load_dwordx4 v[164:167], v13, s[32:35], s62 offen offset:2048 nt
    buffer_load_dwordx4 v[168:171], v13, s[32:35], s62 offen offset:2560 nt
    buffer_load_dwordx4 v[172:175], v13, s[32:35], s62 offen offset:3072 nt
    buffer_load_dwordx4 v[176:179], v13, s[32:35], s62 offen offset:3584 nt
    s_branch L_p1_c
L_p1_b:
    buffer_load_dwordx4 v[148:151], v13, s[32:35], s62 offen offset:0 sc1
    buffer_load_dwordx4 v[152:155], v13, s[32:35], s62 offen offset:512 sc1
    buffer_load_dwordx4 v[156:159], v13, s[32:35], s62 offen offset:1024 sc1
    buffer_load_dwordx4 v[160:163], v13, s[32:35], s62 offen offset:1536 sc1
    buffer_load_dwordx4 v[164:167], v13, s[32:35], s62 offen offset:2048 sc1
    buffer_load_dwordx4 v[168:171], v13, s[32:35], s62 offen offset:2560 sc1
    buffer_load_dwordx4 v[172:175], v13, s[32:35], s62 offen offset:3072 sc1
    buffer_load_dwordx4 v[176:179], v13, s[32:35], s62 offen offset:3584 sc1
L_p1_c:
    s_waitcnt vmcnt(0)
    v_xor_b32 v14, s56, v149
    v_bitop3_b32 v14, v151, s56, v14 bitop3:0xbe
    v_bitop3_b32 v14, v153, s56, v14 bitop3:0xbe
    v_bitop3_b32 v14, v155, s56, v14 bitop3:0xbe
    v_bitop3_b32 v14, v157, s56, v14 bitop3:0xbe
    v_bitop3_b32 v14, v159, s56, v14 bitop3:0xbe
    v_bitop3_b32 v14, v161, s56, v14 bitop3:0xbe
    v_bitop3_b32 v14, v163, s56, v14 bitop3:0xbe
    v_bitop3_b32 v14, v165, s56, v14 bitop3:0xbe
    v_bitop3_b32 v14, v167, s56, v14 bitop3:0xbe
    v_bitop3_b32 v14, v169, s56, v14 bitop3:0xbe
    v_bitop3_b32 v14, v171, s56, v14 bitop3:0xbe
    v_bitop3_b32 v14, v173, s56, v14 bitop3:0xbe
    v_bitop3_b32 v14, v175, s56, v14 bitop3:0xbe
    v_bitop3_b32 v14, v177, s56, v14 bitop3:0xbe
    v_bitop3_b32 v14, v179, s56, v14 bitop3:0xbe
    v_cmp_ne_u32 vcc, 0, v14
    s_add_u32 s61, s61, 1
    s_cbranch_vccz L_p1_x
    s_cmp_gt_u32 s61, 400000
    s_cbranch_scc1 L_p1_x
    s_and_b64 exec, exec, vcc
    s_branch L_p1
L_p1_x:
    s_mov_b64 exec, -1
    s_cmp_gt_u32 s61, 31
    s_cbranch_scc1 L_p1m
    s_mov_b64 s[98:99], exec
    s_mov_b32 exec_lo, 0x55555555
    s_mov_b32 exec_hi, 0
    buffer_store_dwordx2 v[238:239], v237, s[32:35], s71 offen sc1
    s_mov_b64 exec, s[98:99]
L_p1m:
    v_mov_b32 v149, v150
    v_mov_b32 v150, v152
    v_mov_b32 v151, v154
    v_mov_b32 v157, v158
    v_mov_b32 v158, v160
    v_mov_b32 v159, v162
    v_mov_b32 v165, v166
    v_mov_b32 v166, v168
    v_mov_b32 v167, v170
    v_mov_b32 v173, v174
    v_mov_b32 v174, v176
    v_mov_b32 v175, v178
    s_waitcnt lgkmcnt(0)
    v_mfma_f32_16x16x32_bf16 v[180:183], v[148:151], v[116:119], 0
    v_mfma_f32_16x16x32_bf16 v[184:187], v[148:151], v[132:135], 0
    v_mfma_f32_16x16x32_bf16 v[180:183], v[156:159], v[120:123], v[180:183]
    v_mfma_f32_16x16x32_bf16 v[184:187], v[156:159], v[136:139], v[184:187]
    v_mfma_f32_16x16x32_bf16 v[180:183], v[164:167], v[124:127], v[180:183]
    v_mfma_f32_16x16x32_bf16 v[184:187], v[164:167], v[140:143], v[184:187]
    v_mfma_f32_16x16x32_bf16 v[180:183], v[172:175], v[128:131], v[180:183]
    v_mfma_f32_16x16x32_bf16 v[184:187], v[172:175], v[144:147], v[184:187]
    s_mov_b32 s63, 0x3e0293ee
    v_lshlrev_b32 v13, 2, v3
    v_lshl_add_u32 v13, v4, 6, v13
    v_cmp_eq_u32 vcc, 1, v4
    s_lshl_b32 s62, s58, 9
    s_lshl_b32 s64, s57, 7
    s_add_u32 s62, s62, s64
    s_add_u32 s62, s62, 135168
    v_add_f32 v180, v180, v181
    v_add_f32 v184, v184, v185
    v_add_f32 v182, v182, v183
    v_add_f32 v186, v186, v187
    v_add_f32 v180, v180, v182
    v_add_f32 v184, v184, v186
    v_mov_b32 v181, v180
    v_mov_b32 v185, v184
    s_nop 0
    v_permlane16_swap_b32 v180, v181
    v_permlane16_swap_b32 v184, v185
    v_add_f32 v180, v180, v181
    v_add_f32 v184, v184, v185
    v_cndmask_b32 v180, v180, v184, vcc
    v_mul_f32 v180, s63, v180
    s_nop 1
    v_mov_b32_dpp v181, v180 row_shl:1 row_mask:0xf bank_mask:0xf
    v_cvt_pk_bf16_f32 v188, v180, v181
    v_mov_b32 v189, s56
    s_mov_b32 exec_lo, 0x55555555
    s_mov_b32 exec_hi, 0
    buffer_store_dwordx2 v[188:189], v13, s[32:35], s62 offen sc1
    s_mov_b64 exec, -1
    v_lshrrev_b32 v15, 1, v3
    v_and_b32 v16, 1, v4
    v_lshlrev_b32 v16, 2, v16
    v_xor_b32 v15, v15, v16
    v_lshlrev_b32 v15, 5, v15
    v_and_b32 v16, 1, v0
    v_lshl_add_u32 v15, v16, 4, v15
    v_lshl_add_u32 v15, v4, 13, v15
    s_lshl_b32 s62, s57, 1
    s_and_b32 s63, s62, 3
    s_lshl_b32 s63, s63, 5
    v_xor_b32 v16, s63, v15
    s_add_u32 s62, s62, 1
    s_and_b32 s63, s62, 3
    s_lshl_b32 s63, s63, 5
    v_xor_b32 v15, s63, v15
    s_lshl_b32 s62, s60, 20
    s_lshl_b32 s63, s59, 8
    s_add_u32 s62, s62, s63
    s_lshl_b32 s63, s57, 18
    s_add_u32 s62, s62, s63
    s_lshl_b32 s63, s57, 13
    s_add_u32 s63, s63, 32768
    s_mov_b32 m0, s63
    s_add_u32 s63, s63, 1024
    buffer_load_dwordx4 v16, s[48:51], s62 offen nt lds
    s_add_u32 s62, s62, 32768
    s_mov_b32 m0, s63
    s_add_u32 s63, s63, 1024
    buffer_load_dwordx4 v16, s[48:51], s62 offen nt lds
    s_add_u32 s62, s62, 32768
    s_mov_b32 m0, s63
    s_add_u32 s63, s63, 1024
    buffer_load_dwordx4 v16, s[48:51], s62 offen nt lds
    s_add_u32 s62, s62, 32768
    s_mov_b32 m0, s63
    s_add_u32 s63, s63, 1024
    buffer_load_dwordx4 v16, s[48:51], s62 offen nt lds
    s_add_u32 s62, s62, 32768
    s_mov_b32 m0, s63
    s_add_u32 s63, s63, 1024
    buffer_load_dwordx4 v15, s[48:51], s62 offen nt lds
    s_add_u32 s62, s62, 32768
    s_mov_b32 m0, s63
    s_add_u32 s63, s63, 1024
    buffer_load_dwordx4 v15, s[48:51], s62 offen nt lds
    s_add_u32 s62, s62, 32768
    s_mov_b32 m0, s63
    s_add_u32 s63, s63, 1024
    buffer_load_dwordx4 v15, s[48:51], s62 offen nt lds
    s_add_u32 s62, s62, 32768
    s_mov_b32 m0, s63
    s_add_u32 s63, s63, 1024
    buffer_load_dwordx4 v15, s[48:51], s62 offen nt lds
    v_lshlrev_b32 v17, 2, v0
    s_mov_b32 s52, s18
    s_mov_b32 s53, s19
    s_mov_b32 s54, 3456
    s_mov_b32 s55, 0x00020000
    buffer_load_dword v196, v17, s[52:55], 0 offen offset:0
    buffer_load_dword v197, v17, s[52:55], 0 offen offset:1024
    buffer_load_dword v198, v17, s[52:55], 0 offen offset:2048
    buffer_load_dword v199, v17, s[52:55], 0 offen offset:3072
    s_mov_b32 s52, s20
    s_mov_b32 s53, s21
    s_mov_b32 s54, 3456
    s_mov_b32 s55, 0x00020000
    buffer_load_dword v200, v17, s[52:55], 0 offen offset:0
    buffer_load_dword v201, v17, s[52:55], 0 offen offset:1024
    buffer_load_dword v202, v17, s[52:55], 0 offen offset:2048
    buffer_load_dword v203, v17, s[52:55], 0 offen offset:3072
    s_mov_b32 s52, s22
    s_mov_b32 s53, s23
    s_mov_b32 s54, 3456
    s_mov_b32 s55, 0x00020000
    buffer_load_dword v204, v17, s[52:55], 0 offen offset:0
    buffer_load_dword v205, v17, s[52:55], 0 offen offset:1024
    buffer_load_dword v206, v17, s[52:55], 0 offen offset:2048
    buffer_load_dword v207, v17, s[52:55], 0 offen offset:3072
    s_mov_b32 s52, s24
    s_mov_b32 s53, s25
    s_mov_b32 s54, 2
    s_mov_b32 s55, 0x00020000
    buffer_load_ushort v208, v18, s[52:55], 0 offen
    v_lshlrev_b32 v245, 3, v0
    buffer_load_dwordx2 v[246:247], v245, s[36:39], 0 offen
    s_and_b32 s62, s2, 7
    s_lshl_b32 s62, s62, 7
    s_add_u32 s62, s62, 1191936
    v_lshlrev_b32 v249, 2, v1
    v_and_b32 v249, 127, v249
    buffer_load_dword v252, v249, s[32:35], s62 offen nt
    s_waitcnt vmcnt(0)
    s_barrier
    v_lshrrev_b32 v19, 2, v3
    v_lshl_add_u32 v19, v4, 2, v19
    v_lshrrev_b32 v20, 2, v3
    v_and_b32 v21, 1, v4
    v_lshl_add_u32 v21, v21, 2, v20
    s_lshl_b32 s62, s57, 1
    v_xor_b32 v21, s62, v21
    v_lshlrev_b32 v21, 5, v21
    v_lshl_add_u32 v20, v20, 4, v4
    v_lshl_add_u32 v20, v20, 8, v21
    v_and_b32 v21, 3, v3
    v_lshl_add_u32 v20, v21, 3, v20
    v_xor_b32 v21, 32, v20
    ds_read_b64_tr_b16 v[60:61], v20 offset:32768
    ds_read_b64_tr_b16 v[62:63], v20 offset:33792
    ds_read_b64_tr_b16 v[64:65], v20 offset:34816
    ds_read_b64_tr_b16 v[66:67], v20 offset:35840
    ds_read_b64_tr_b16 v[68:69], v20 offset:49152
    ds_read_b64_tr_b16 v[70:71], v20 offset:50176
    ds_read_b64_tr_b16 v[72:73], v20 offset:51200
    ds_read_b64_tr_b16 v[74:75], v20 offset:52224
    ds_read_b64_tr_b16 v[76:77], v21 offset:32768
    ds_read_b64_tr_b16 v[78:79], v21 offset:33792
    ds_read_b64_tr_b16 v[80:81], v21 offset:34816
    ds_read_b64_tr_b16 v[82:83], v21 offset:35840
    ds_read_b64_tr_b16 v[84:85], v21 offset:49152
    ds_read_b64_tr_b16 v[86:87], v21 offset:50176
    ds_read_b64_tr_b16 v[88:89], v21 offset:51200
    ds_read_b64_tr_b16 v[90:91], v21 offset:52224
    s_mov_b32 s63, 0xffff0000
    v_lshlrev_b32 v210, 16, v196
    v_and_b32 v211, s63, v196
    v_lshlrev_b32 v212, 16, v197
    v_and_b32 v213, s63, v197
    v_lshlrev_b32 v214, 16, v198
    v_and_b32 v215, s63, v198
    v_lshlrev_b32 v216, 16, v199
    v_and_b32 v217, s63, v199
    v_lshlrev_b32 v218, 16, v200
    v_and_b32 v219, s63, v200
    v_lshlrev_b32 v220, 16, v201
    v_and_b32 v221, s63, v201
    v_lshlrev_b32 v222, 16, v202
    v_and_b32 v223, s63, v202
    v_lshlrev_b32 v224, 16, v203
    v_and_b32 v225, s63, v203
    v_lshlrev_b32 v226, 16, v204
    v_and_b32 v227, s63, v204
    v_lshlrev_b32 v228, 16, v205
    v_and_b32 v229, s63, v205
    v_lshlrev_b32 v230, 16, v206
    v_and_b32 v231, s63, v206
    v_lshlrev_b32 v232, 16, v207
    v_and_b32 v233, s63, v207
    v_lshlrev_b32 v208, 16, v208
    v_lshlrev_b32 v22, 4, v0
    v_and_b32 v23, 31, v1
    v_lshlrev_b32 v23, 9, v23
    s_lshl_b32 s62, s58, 14
    s_add_u32 s66, s62, 2101248
    s_add_u32 s67, s66, 4096
    s_add_u32 s68, s66, 8192
    s_add_u32 s69, s66, 12288
    s_lshr_b32 s62, s59, 3
    s_lshl_b32 s62, s62, 7
    s_and_b32 s63, s59, 7
    s_lshl_b32 s63, s63, 4
    s_add_u32 s62, s62, s63
    s_add_u32 s70, s62, 200704
    v_lshrrev_b32 v24, 5, v0
    v_mul_u32_u24 v24, 288, v24
    v_and_b32 v25, 31, v0
    v_lshl_add_u32 v24, v25, 3, v24
    v_add_u32 v24, 65536, v24
    s_lshl_b32 s62, s57, 7
    s_add_u32 s71, s62, 82944
    v_and_b32 v25, 31, v1
    v_lshlrev_b32 v25, 2, v25
    v_add_u32 v25, s71, v25
    v_lshlrev_b32 v27, 4, v4
    v_add_u32 v27, s71, v27
    v_mul_u32_u24 v28, 288, v19
    v_and_b32 v29, 3, v3
    v_lshl_add_u32 v28, v29, 3, v28
    v_add_u32 v28, 65536, v28
    s_lshl_b32 s72, s59, 11
    s_lshl_b32 s63, s57, 9
    s_add_u32 s72, s72, s63
    s_lshl_b32 s63, s60, 4
    s_add_u32 s72, s72, s63
    s_add_u32 s72, s72, 217088
    s_add_u32 s73, s72, 233472
    v_lshrrev_b32 v30, 2, v3
    v_lshlrev_b32 v30, 6, v30
    v_bfe_u32 v14, v3, 1, 1
    v_lshl_add_u32 v30, v14, 3, v30
    v_lshl_add_u32 v30, v4, 8, v30
    v_cmp_eq_u32 s[8:9], 1, v4
    s_mov_b32 exec_hi, 0
    s_mov_b32 s61, 0
L_p3a:
    buffer_load_dwordx4 v[116:119], v23, s[32:35], s70 offen sc1
    s_waitcnt vmcnt(0)
    v_xor_b32 v14, s56, v117
    v_bitop3_b32 v14, v119, s56, v14 bitop3:0xbe
    v_cmp_ne_u32 vcc, 0, v14
    s_add_u32 s61, s61, 1
    s_cbranch_vccz L_p3a_x
    s_cmp_gt_u32 s61, 400000
    s_cbranch_scc1 L_p3a_x
    s_and_b64 exec, exec, vcc
    s_branch L_p3a
L_p3a_x:
    s_mov_b64 exec, -1
    buffer_load_dwordx4 v[100:103], v22, s[32:35], s66 offen sc1
    buffer_load_dwordx4 v[104:107], v22, s[32:35], s67 offen sc1
    buffer_load_dwordx4 v[108:111], v22, s[32:35], s68 offen sc1
    buffer_load_dwordx4 v[112:115], v22, s[32:35], s69 offen sc1
    v_mov_b32 v120, v116
    s_nop 1
    v_max_f32_dpp v120, v120, v120 quad_perm:[1,0,3,2] row_mask:0xf bank_mask:0xf
    s_nop 1
    v_max_f32_dpp v120, v120, v120 quad_perm:[2,3,0,1] row_mask:0xf bank_mask:0xf
    s_nop 1
    v_max_f32_dpp v120, v120, v120 row_half_mirror row_mask:0xf bank_mask:0xf
    s_nop 1
    v_max_f32_dpp v120, v120, v120 row_mirror row_mask:0xf bank_mask:0xf
    v_mov_b32 v121, v120
    s_nop 1
    v_permlane16_swap_b32 v120, v121
    v_max_f32 v120, v120, v121
    v_sub_f32 v116, v116, v120
    v_exp_f32 v116, v116
    s_nop 0
    v_mul_f32 v118, v116, v118
    s_nop 1
    v_add_f32_dpp v118, v118, v118 quad_perm:[1,0,3,2] row_mask:0xf bank_mask:0xf
    s_nop 1
    v_add_f32_dpp v118, v118, v118 quad_perm:[2,3,0,1] row_mask:0xf bank_mask:0xf
    s_nop 1
    v_add_f32_dpp v118, v118, v118 row_half_mirror row_mask:0xf bank_mask:0xf
    s_nop 1
    v_add_f32_dpp v118, v118, v118 row_mirror row_mask:0xf bank_mask:0xf
    v_mov_b32 v121, v118
    s_nop 1
    v_permlane16_swap_b32 v118, v121
    v_add_f32 v118, v118, v121
    v_rcp_f32 v118, v118
    s_nop 0
    v_mul_f32 v116, v116, v118
    s_mov_b32 exec_hi, 0
    ds_write_b32 v25, v116
    s_mov_b64 exec, -1
    ds_read_b128 v[120:123], v27
    ds_read_b128 v[124:127], v27 offset:64
    s_waitcnt vmcnt(0)
    v_xor_b32 v14, s56, v101
    v_bitop3_b32 v14, v103, s56, v14 bitop3:0xbe
    v_bitop3_b32 v14, v105, s56, v14 bitop3:0xbe
    v_bitop3_b32 v14, v107, s56, v14 bitop3:0xbe
    v_bitop3_b32 v14, v109, s56, v14 bitop3:0xbe
    v_bitop3_b32 v14, v111, s56, v14 bitop3:0xbe
    v_bitop3_b32 v14, v113, s56, v14 bitop3:0xbe
    v_bitop3_b32 v14, v115, s56, v14 bitop3:0xbe
    v_cmp_ne_u32 vcc, 0, v14
    s_cbranch_vccz L_p3b_x
    s_and_b64 exec, exec, vcc
    s_mov_b32 s61, 0
L_p3b:
    buffer_load_dwordx4 v[100:103], v22, s[32:35], s66 offen sc1
    buffer_load_dwordx4 v[104:107], v22, s[32:35], s67 offen sc1
    buffer_load_dwordx4 v[108:111], v22, s[32:35], s68 offen sc1
    buffer_load_dwordx4 v[112:115], v22, s[32:35], s69 offen sc1
    s_waitcnt vmcnt(0)
    v_xor_b32 v14, s56, v101
    v_bitop3_b32 v14, v103, s56, v14 bitop3:0xbe
    v_bitop3_b32 v14, v105, s56, v14 bitop3:0xbe
    v_bitop3_b32 v14, v107, s56, v14 bitop3:0xbe
    v_bitop3_b32 v14, v109, s56, v14 bitop3:0xbe
    v_bitop3_b32 v14, v111, s56, v14 bitop3:0xbe
    v_bitop3_b32 v14, v113, s56, v14 bitop3:0xbe
    v_bitop3_b32 v14, v115, s56, v14 bitop3:0xbe
    v_cmp_ne_u32 vcc, 0, v14
    s_add_u32 s61, s61, 1
    s_cbranch_vccz L_p3b_x
    s_cmp_gt_u32 s61, 400000
    s_cbranch_scc1 L_p3b_x
    s_and_b64 exec, exec, vcc
    s_branch L_p3b
L_p3b_x:
    s_mov_b64 exec, -1
    v_mov_b32 v101, v102
    ds_write_b64 v24, v[100:101] offset:0
    v_mov_b32 v105, v106
    ds_write_b64 v24, v[104:105] offset:2304
    v_mov_b32 v109, v110
    ds_write_b64 v24, v[108:109] offset:4608
    v_mov_b32 v113, v114
    ds_write_b64 v24, v[112:113] offset:6912
    s_waitcnt lgkmcnt(0)
    s_barrier
    ds_read_b64_tr_b16 v[132:133], v28 offset:0
    ds_read_b64_tr_b16 v[134:135], v28 offset:4608
    ds_read_b64_tr_b16 v[136:137], v28 offset:32
    ds_read_b64_tr_b16 v[138:139], v28 offset:4640
    ds_read_b64_tr_b16 v[140:141], v28 offset:64
    ds_read_b64_tr_b16 v[142:143], v28 offset:4672
    ds_read_b64_tr_b16 v[144:145], v28 offset:96
    ds_read_b64_tr_b16 v[146:147], v28 offset:4704
    ds_read_b64_tr_b16 v[148:149], v28 offset:128
    ds_read_b64_tr_b16 v[150:151], v28 offset:4736
    ds_read_b64_tr_b16 v[152:153], v28 offset:160
    ds_read_b64_tr_b16 v[154:155], v28 offset:4768
    ds_read_b64_tr_b16 v[156:157], v28 offset:192
    ds_read_b64_tr_b16 v[158:159], v28 offset:4800
    ds_read_b64_tr_b16 v[160:161], v28 offset:224
    ds_read_b64_tr_b16 v[162:163], v28 offset:4832
    v_cvt_pk_bf16_f32 v128, v120, v121
    v_cvt_pk_bf16_f32 v129, v122, v123
    v_cvt_pk_bf16_f32 v130, v124, v125
    v_cvt_pk_bf16_f32 v131, v126, v127
    s_waitcnt lgkmcnt(14)
    s_nop 0
    v_mfma_f32_16x16x32_bf16 v[164:167], v[132:135], v[128:131], 0
    s_waitcnt lgkmcnt(12)
    v_mfma_f32_16x16x32_bf16 v[168:171], v[136:139], v[128:131], 0
    s_waitcnt lgkmcnt(10)
    v_mfma_f32_16x16x32_bf16 v[172:175], v[140:143], v[128:131], 0
    s_waitcnt lgkmcnt(8)
    v_mfma_f32_16x16x32_bf16 v[176:179], v[144:147], v[128:131], 0
    s_waitcnt lgkmcnt(6)
    v_mfma_f32_16x16x32_bf16 v[180:183], v[148:151], v[128:131], 0
    s_waitcnt lgkmcnt(4)
    v_mfma_f32_16x16x32_bf16 v[184:187], v[152:155], v[128:131], 0
    s_waitcnt lgkmcnt(2)
    v_mfma_f32_16x16x32_bf16 v[188:191], v[156:159], v[128:131], 0
    s_waitcnt lgkmcnt(0)
    v_mfma_f32_16x16x32_bf16 v[192:195], v[160:163], v[128:131], 0
    v_cvt_pk_bf16_f32 v100, v164, v165
    v_cvt_pk_bf16_f32 v101, v166, v167
    v_cvt_pk_bf16_f32 v102, v168, v169
    v_cvt_pk_bf16_f32 v103, v170, v171
    v_cvt_pk_bf16_f32 v104, v172, v173
    v_cvt_pk_bf16_f32 v105, v174, v175
    v_cvt_pk_bf16_f32 v106, v176, v177
    v_cvt_pk_bf16_f32 v107, v178, v179
    v_cvt_pk_bf16_f32 v108, v180, v181
    v_cvt_pk_bf16_f32 v109, v182, v183
    v_cvt_pk_bf16_f32 v110, v184, v185
    v_cvt_pk_bf16_f32 v111, v186, v187
    v_cvt_pk_bf16_f32 v112, v188, v189
    v_cvt_pk_bf16_f32 v113, v190, v191
    v_cvt_pk_bf16_f32 v114, v192, v193
    v_cvt_pk_bf16_f32 v115, v194, v195
    v_mfma_f32_16x16x32_bf16 v[116:119], v[100:103], v[60:63], 0
    v_mfma_f32_16x16x32_bf16 v[120:123], v[100:103], v[76:79], 0
    v_mfma_f32_16x16x32_bf16 v[116:119], v[104:107], v[64:67], v[116:119]
    v_mfma_f32_16x16x32_bf16 v[120:123], v[104:107], v[80:83], v[120:123]
    v_mfma_f32_16x16x32_bf16 v[116:119], v[108:111], v[68:71], v[116:119]
    v_mfma_f32_16x16x32_bf16 v[120:123], v[108:111], v[84:87], v[120:123]
    v_mfma_f32_16x16x32_bf16 v[116:119], v[112:115], v[72:75], v[116:119]
    v_mfma_f32_16x16x32_bf16 v[120:123], v[112:115], v[88:91], v[120:123]
    s_nop 7
    v_cndmask_b32 v116, v116, v120, s[8:9]
    s_nop 1
    v_mov_b32_dpp v117, v116 row_shl:1 row_mask:0xf bank_mask:0xf
    v_cvt_pk_bf16_f32 v118, v116, v117
    v_mov_b32 v119, s56
    s_mov_b32 exec_lo, 0x55555555
    s_mov_b32 exec_hi, 0
    buffer_store_dwordx2 v[118:119], v30, s[32:35], s72 offen
    buffer_store_dwordx2 v[118:119], v30, s[32:35], s73 offen sc1
    s_mov_b64 exec, -1
    s_branch L_M
L_Y:
    v_lshlrev_b32 v5, 4, v1
    s_add_u32 s62, s60, 0
    s_and_b32 s62, s62, 3
    s_add_u32 s63, s69, 0
    s_lshl_b32 s62, s62, 13
    s_add_u32 s62, s62, s68
    s_mov_b32 m0, s63
    s_add_u32 s63, s63, 1056
    buffer_load_dwordx4 v9, s[44:47], s62 offen lds
    s_add_u32 s62, s62, 1024
    s_mov_b32 m0, s63
    s_add_u32 s63, s63, 1056
    buffer_load_dwordx4 v9, s[44:47], s62 offen lds
    s_add_u32 s62, s62, 1024
    s_mov_b32 m0, s63
    s_add_u32 s63, s63, 1056
    buffer_load_dwordx4 v9, s[44:47], s62 offen lds
    s_add_u32 s62, s62, 1024
    s_mov_b32 m0, s63
    s_add_u32 s63, s63, 1056
    buffer_load_dwordx4 v9, s[44:47], s62 offen lds
    s_add_u32 s62, s62, 1024
    s_mov_b32 m0, s63
    s_add_u32 s63, s63, 1056
    buffer_load_dwordx4 v9, s[44:47], s62 offen lds
    s_add_u32 s62, s62, 1024
    s_mov_b32 m0, s63
    s_add_u32 s63, s63, 1056
    buffer_load_dwordx4 v9, s[44:47], s62 offen lds
    s_add_u32 s62, s62, 1024
    s_mov_b32 m0, s63
    s_add_u32 s63, s63, 1056
    buffer_load_dwordx4 v9, s[44:47], s62 offen lds
    s_add_u32 s62, s62, 1024
    s_mov_b32 m0, s63
    s_add_u32 s63, s63, 1056
    buffer_load_dwordx4 v9, s[44:47], s62 offen lds
    s_add_u32 s62, s60, 1
    s_and_b32 s62, s62, 3
    s_add_u32 s63, s69, 8448
    s_lshl_b32 s62, s62, 13
    s_add_u32 s62, s62, s68
    s_mov_b32 m0, s63
    s_add_u32 s63, s63, 1056
    buffer_load_dwordx4 v9, s[44:47], s62 offen lds
    s_add_u32 s62, s62, 1024
    s_mov_b32 m0, s63
    s_add_u32 s63, s63, 1056
    buffer_load_dwordx4 v9, s[44:47], s62 offen lds
    s_add_u32 s62, s62, 1024
    s_mov_b32 m0, s63
    s_add_u32 s63, s63, 1056
    buffer_load_dwordx4 v9, s[44:47], s62 offen lds
    s_add_u32 s62, s62, 1024
    s_mov_b32 m0, s63
    s_add_u32 s63, s63, 1056
    buffer_load_dwordx4 v9, s[44:47], s62 offen lds
    s_add_u32 s62, s62, 1024
    s_mov_b32 m0, s63
    s_add_u32 s63, s63, 1056
    buffer_load_dwordx4 v9, s[44:47], s62 offen lds
    s_add_u32 s62, s62, 1024
    s_mov_b32 m0, s63
    s_add_u32 s63, s63, 1056
    buffer_load_dwordx4 v9, s[44:47], s62 offen lds
    s_add_u32 s62, s62, 1024
    s_mov_b32 m0, s63
    s_add_u32 s63, s63, 1056
    buffer_load_dwordx4 v9, s[44:47], s62 offen lds
    s_add_u32 s62, s62, 1024
    s_mov_b32 m0, s63
    s_add_u32 s63, s63, 1056
    buffer_load_dwordx4 v9, s[44:47], s62 offen lds
    s_add_u32 s62, s60, 2
    s_and_b32 s62, s62, 3
    s_add_u32 s63, s69, 16896
    s_lshl_b32 s62, s62, 13
    s_add_u32 s62, s62, s68
    s_mov_b32 m0, s63
    s_add_u32 s63, s63, 1056
    buffer_load_dwordx4 v9, s[44:47], s62 offen lds
    s_add_u32 s62, s62, 1024
    s_mov_b32 m0, s63
    s_add_u32 s63, s63, 1056
    buffer_load_dwordx4 v9, s[44:47], s62 offen lds
    s_add_u32 s62, s62, 1024
    s_mov_b32 m0, s63
    s_add_u32 s63, s63, 1056
    buffer_load_dwordx4 v9, s[44:47], s62 offen lds
    s_add_u32 s62, s62, 1024
    s_mov_b32 m0, s63
    s_add_u32 s63, s63, 1056
    buffer_load_dwordx4 v9, s[44:47], s62 offen lds
    s_add_u32 s62, s62, 1024
    s_mov_b32 m0, s63
    s_add_u32 s63, s63, 1056
    buffer_load_dwordx4 v9, s[44:47], s62 offen lds
    s_add_u32 s62, s62, 1024
    s_mov_b32 m0, s63
    s_add_u32 s63, s63, 1056
    buffer_load_dwordx4 v9, s[44:47], s62 offen lds
    s_add_u32 s62, s62, 1024
    s_mov_b32 m0, s63
    s_add_u32 s63, s63, 1056
    buffer_load_dwordx4 v9, s[44:47], s62 offen lds
    s_add_u32 s62, s62, 1024
    s_mov_b32 m0, s63
    s_add_u32 s63, s63, 1056
    buffer_load_dwordx4 v9, s[44:47], s62 offen lds
    s_add_u32 s62, s60, 3
    s_and_b32 s62, s62, 3
    s_add_u32 s63, s69, 25344
    s_lshl_b32 s62, s62, 13
    s_add_u32 s62, s62, s68
    s_mov_b32 m0, s63
    s_add_u32 s63, s63, 1056
    buffer_load_dwordx4 v9, s[44:47], s62 offen lds
    s_add_u32 s62, s62, 1024
    s_mov_b32 m0, s63
    s_add_u32 s63, s63, 1056
    buffer_load_dwordx4 v9, s[44:47], s62 offen lds
    s_add_u32 s62, s62, 1024
    s_mov_b32 m0, s63
    s_add_u32 s63, s63, 1056
    buffer_load_dwordx4 v9, s[44:47], s62 offen lds
    s_add_u32 s62, s62, 1024
    s_mov_b32 m0, s63
    s_add_u32 s63, s63, 1056
    buffer_load_dwordx4 v9, s[44:47], s62 offen lds
    s_add_u32 s62, s62, 1024
    s_mov_b32 m0, s63
    s_add_u32 s63, s63, 1056
    buffer_load_dwordx4 v9, s[44:47], s62 offen lds
    s_add_u32 s62, s62, 1024
    s_mov_b32 m0, s63
    s_add_u32 s63, s63, 1056
    buffer_load_dwordx4 v9, s[44:47], s62 offen lds
    s_add_u32 s62, s62, 1024
    s_mov_b32 m0, s63
    s_add_u32 s63, s63, 1056
    buffer_load_dwordx4 v9, s[44:47], s62 offen lds
    s_add_u32 s62, s62, 1024
    s_mov_b32 m0, s63
    s_add_u32 s63, s63, 1056
    buffer_load_dwordx4 v9, s[44:47], s62 offen lds
    s_mov_b32 s44, s14
    s_mov_b32 s45, s15
    s_mov_b32 s46, 5242880
    s_mov_b32 s47, 0x00020000
    s_bfe_u32 s74, s2, 0x40003
    s_lshl_b32 s62, s57, 5
    v_add_u32 v6, s62, v3
    v_mul_u32_u24 v6, 1056, v6
    v_lshl_add_u32 v6, v4, 4, v6
    v_lshrrev_b32 v19, 2, v3
    v_lshl_add_u32 v19, v4, 2, v19
    v_mul_u32_u24 v7, 1056, v19
    v_and_b32 v8, 3, v3
    v_lshl_add_u32 v7, v8, 3, v7
    s_lshl_b32 s62, s57, 8
    v_add_u32 v7, s62, v7
    v_add_u32 v8, 67584, v7
    v_lshlrev_b32 v22, 4, v0
    s_lshl_b32 s62, s60, 14
    s_add_u32 s66, s62, 135168
    s_add_u32 s67, s66, 4096
    s_add_u32 s68, s66, 8192
    s_add_u32 s69, s66, 12288
    v_lshrrev_b32 v24, 7, v0
    v_mul_u32_u24 v24, 1056, v24
    v_and_b32 v25, 127, v0
    v_lshl_add_u32 v24, v25, 3, v24
    v_add_u32 v24, 135168, v24
    v_and_b32 v25, 7, v3
    v_mul_u32_u24 v25, 1056, v25
    v_lshl_add_u32 v25, v4, 4, v25
    v_add_u32 v25, 135168, v25
    s_lshl_b32 s62, s57, 2
    s_add_u32 s62, s62, 147712
    v_lshlrev_b32 v26, 4, v3
    v_add_u32 v27, s62, v26
    v_add_u32 v28, 147712, v26
    s_lshl_b32 s62, s57, 10
    s_add_u32 s62, s62, 143616
    v_add_u32 v29, s62, v5
    v_add_u32 v31, 143616, v5
    v_mov_b32 v184, 0x3f803f80
    v_mov_b32 v185, 0x3f803f80
    v_mov_b32 v186, 0x3f803f80
    v_mov_b32 v187, 0x3f803f80
    s_and_b32 s62, s2, 7
    s_lshl_b32 s62, s62, 7
    s_bfe_u32 s63, s2, 0x40003
    s_lshl_b32 s63, s63, 2
    s_add_u32 s62, s62, s63
    s_add_u32 s62, s62, 1192960
    v_mov_b32 v183, s62
    v_and_b32 v21, 1, v3
    v_cmp_eq_u32 s[8:9], 1, v21
    v_and_b32 v21, 2, v3
    v_cmp_eq_u32 s[10:11], 2, v21
    v_and_b32 v30, 1, v4
    v_lshlrev_b32 v30, 18, v30
    v_lshl_add_u32 v30, v3, 4, v30
    v_lshrrev_b32 v21, 1, v4
    v_lshl_add_u32 v30, v21, 17, v30
    v_cmp_eq_u32 s[12:13], 1, v21
    s_lshl_b32 s73, s60, 19
    s_lshl_b32 s63, s57, 14
    s_add_u32 s73, s73, s63
    s_lshl_b32 s63, s59, 9
    s_add_u32 s73, s73, s63
    s_add_u32 s73, s73, 2101248
    s_lshl_b32 s72, s58, 7
    s_add_u32 s72, s72, 200704
    s_waitcnt vmcnt(16)
    ds_read_b128 a[0:3], v6 offset:0
    ds_read_b128 a[4:7], v6 offset:64
    ds_read_b128 a[8:11], v6 offset:128
    ds_read_b128 a[12:15], v6 offset:192
    ds_read_b128 a[16:19], v6 offset:256
    ds_read_b128 a[20:23], v6 offset:320
    ds_read_b128 a[24:27], v6 offset:384
    ds_read_b128 a[28:31], v6 offset:448
    ds_read_b128 a[32:35], v6 offset:512
    ds_read_b128 a[36:39], v6 offset:576
    ds_read_b128 a[40:43], v6 offset:640
    ds_read_b128 a[44:47], v6 offset:704
    ds_read_b128 a[48:51], v6 offset:768
    ds_read_b128 a[52:55], v6 offset:832
    ds_read_b128 a[56:59], v6 offset:896
    ds_read_b128 a[60:63], v6 offset:960
    buffer_load_dwordx4 v[100:103], v22, s[32:35], s66 offen sc1
    buffer_load_dwordx4 v[104:107], v22, s[32:35], s67 offen sc1
    buffer_load_dwordx4 v[108:111], v22, s[32:35], s68 offen sc1
    buffer_load_dwordx4 v[112:115], v22, s[32:35], s69 offen sc1
    s_waitcnt vmcnt(4)
    ds_read_b128 a[64:67], v6 offset:16896
    ds_read_b128 a[68:71], v6 offset:16960
    ds_read_b128 a[72:75], v6 offset:17024
    ds_read_b128 a[76:79], v6 offset:17088
    ds_read_b128 a[80:83], v6 offset:17152
    ds_read_b128 a[84:87], v6 offset:17216
    ds_read_b128 a[88:91], v6 offset:17280
    ds_read_b128 a[92:95], v6 offset:17344
    ds_read_b128 a[96:99], v6 offset:17408
    ds_read_b128 a[100:103], v6 offset:17472
    ds_read_b128 a[104:107], v6 offset:17536
    ds_read_b128 a[108:111], v6 offset:17600
    ds_read_b128 a[112:115], v6 offset:17664
    ds_read_b128 a[116:119], v6 offset:17728
    ds_read_b128 a[120:123], v6 offset:17792
    ds_read_b128 a[124:127], v6 offset:17856
    s_waitcnt vmcnt(0)
    v_xor_b32 v14, s56, v101
    v_bitop3_b32 v14, v103, s56, v14 bitop3:0xbe
    v_bitop3_b32 v14, v105, s56, v14 bitop3:0xbe
    v_bitop3_b32 v14, v107, s56, v14 bitop3:0xbe
    v_bitop3_b32 v14, v109, s56, v14 bitop3:0xbe
    v_bitop3_b32 v14, v111, s56, v14 bitop3:0xbe
    v_bitop3_b32 v14, v113, s56, v14 bitop3:0xbe
    v_bitop3_b32 v14, v115, s56, v14 bitop3:0xbe
    v_cmp_ne_u32 vcc, 0, v14
    s_cbranch_vccz L_p2_x
    s_and_b64 exec, exec, vcc
    s_mov_b32 s61, 0
L_p2:
    buffer_load_dwordx4 v[100:103], v22, s[32:35], s66 offen sc1
    buffer_load_dwordx4 v[104:107], v22, s[32:35], s67 offen sc1
    buffer_load_dwordx4 v[108:111], v22, s[32:35], s68 offen sc1
    buffer_load_dwordx4 v[112:115], v22, s[32:35], s69 offen sc1
    s_waitcnt vmcnt(0)
    v_xor_b32 v14, s56, v101
    v_bitop3_b32 v14, v103, s56, v14 bitop3:0xbe
    v_bitop3_b32 v14, v105, s56, v14 bitop3:0xbe
    v_bitop3_b32 v14, v107, s56, v14 bitop3:0xbe
    v_bitop3_b32 v14, v109, s56, v14 bitop3:0xbe
    v_bitop3_b32 v14, v111, s56, v14 bitop3:0xbe
    v_bitop3_b32 v14, v113, s56, v14 bitop3:0xbe
    v_bitop3_b32 v14, v115, s56, v14 bitop3:0xbe
    v_cmp_ne_u32 vcc, 0, v14
    s_add_u32 s61, s61, 1
    s_cbranch_vccz L_p2_x
    s_cmp_gt_u32 s61, 400000
    s_cbranch_scc1 L_p2_x
    s_and_b64 exec, exec, vcc
    s_branch L_p2
L_p2_x:
    s_mov_b64 exec, -1
    v_mov_b32 v101, v102
    ds_write_b64 v24, v[100:101] offset:0
    v_mov_b32 v105, v106
    ds_write_b64 v24, v[104:105] offset:2112
    v_mov_b32 v109, v110
    ds_write_b64 v24, v[108:109] offset:4224
    v_mov_b32 v113, v114
    ds_write_b64 v24, v[112:113] offset:6336
    s_waitcnt lgkmcnt(0)
    s_barrier
    ds_read_b128 v[32:35], v25 offset:0
    ds_read_b128 v[36:39], v25 offset:64
    ds_read_b128 v[40:43], v25 offset:128
    ds_read_b128 v[44:47], v25 offset:192
    ds_read_b128 v[48:51], v25 offset:256
    ds_read_b128 v[52:55], v25 offset:320
    ds_read_b128 v[56:59], v25 offset:384
    ds_read_b128 v[60:63], v25 offset:448
    ds_read_b128 v[64:67], v25 offset:512
    ds_read_b128 v[68:71], v25 offset:576
    ds_read_b128 v[72:75], v25 offset:640
    ds_read_b128 v[76:79], v25 offset:704
    ds_read_b128 v[80:83], v25 offset:768
    ds_read_b128 v[84:87], v25 offset:832
    ds_read_b128 v[88:91], v25 offset:896
    ds_read_b128 v[92:95], v25 offset:960
    s_mul_i32 s71, s58, 40960
    s_waitcnt lgkmcnt(12)
    v_mfma_f32_16x16x32_bf16 v[100:103], a[0:3], v[32:35], 0
    v_mfma_f32_16x16x32_bf16 v[104:107], a[64:67], v[32:35], 0
    s_waitcnt lgkmcnt(8)
    v_mfma_f32_16x16x32_bf16 v[100:103], a[4:7], v[36:39], v[100:103]
    v_mfma_f32_16x16x32_bf16 v[104:107], a[68:71], v[36:39], v[104:107]
    s_waitcnt lgkmcnt(4)
    v_mfma_f32_16x16x32_bf16 v[100:103], a[8:11], v[40:43], v[100:103]
    v_mfma_f32_16x16x32_bf16 v[104:107], a[72:75], v[40:43], v[104:107]
    buffer_load_dwordx4 v[192:195], v22, s[44:47], s71 offen
    s_add_u32 s71, s71, 4096
    s_waitcnt lgkmcnt(0)
    v_mfma_f32_16x16x32_bf16 v[100:103], a[12:15], v[44:47], v[100:103]
    ds_read_b64_tr_b16 a[128:129], v7 offset:0
    ds_read_b64_tr_b16 a[130:131], v7 offset:16896
    ds_read_b64_tr_b16 a[132:133], v7 offset:33792
    v_mfma_f32_16x16x32_bf16 v[104:107], a[76:79], v[44:47], v[104:107]
    ds_read_b64_tr_b16 a[134:135], v7 offset:50688
    ds_read_b64_tr_b16 a[136:137], v8 offset:0
    ds_read_b64_tr_b16 a[138:139], v8 offset:16896
    v_mfma_f32_16x16x32_bf16 v[100:103], a[16:19], v[48:51], v[100:103]
    ds_read_b64_tr_b16 a[140:141], v8 offset:33792
    ds_read_b64_tr_b16 a[142:143], v8 offset:50688
    ds_read_b64_tr_b16 a[144:145], v7 offset:32
    v_mfma_f32_16x16x32_bf16 v[104:107], a[80:83], v[48:51], v[104:107]
    ds_read_b64_tr_b16 a[146:147], v7 offset:16928
    ds_read_b64_tr_b16 a[148:149], v7 offset:33824
    ds_read_b64_tr_b16 a[150:151], v7 offset:50720
    v_mfma_f32_16x16x32_bf16 v[100:103], a[20:23], v[52:55], v[100:103]
    ds_read_b64_tr_b16 a[152:153], v8 offset:32
    ds_read_b64_tr_b16 a[154:155], v8 offset:16928
    ds_read_b64_tr_b16 a[156:157], v8 offset:33824
    v_mfma_f32_16x16x32_bf16 v[104:107], a[84:87], v[52:55], v[104:107]
    ds_read_b64_tr_b16 a[158:159], v8 offset:50720
    ds_read_b64_tr_b16 a[160:161], v7 offset:64
    ds_read_b64_tr_b16 a[162:163], v7 offset:16960
    buffer_load_dwordx4 v[192:195], v22, s[44:47], s71 offen
    s_add_u32 s71, s71, 4096
    v_mfma_f32_16x16x32_bf16 v[100:103], a[24:27], v[56:59], v[100:103]
    ds_read_b64_tr_b16 a[164:165], v7 offset:33856
    ds_read_b64_tr_b16 a[166:167], v7 offset:50752
    ds_read_b64_tr_b16 a[168:169], v8 offset:64
    v_mfma_f32_16x16x32_bf16 v[104:107], a[88:91], v[56:59], v[104:107]
    ds_read_b64_tr_b16 a[170:171], v8 offset:16960
    ds_read_b64_tr_b16 a[172:173], v8 offset:33856
    ds_read_b64_tr_b16 a[174:175], v8 offset:50752
    v_mfma_f32_16x16x32_bf16 v[100:103], a[28:31], v[60:63], v[100:103]
    ds_read_b64_tr_b16 a[176:177], v7 offset:96
    ds_read_b64_tr_b16 a[178:179], v7 offset:16992
    ds_read_b64_tr_b16 a[180:181], v7 offset:33888
    v_mfma_f32_16x16x32_bf16 v[104:107], a[92:95], v[60:63], v[104:107]
    ds_read_b64_tr_b16 a[182:183], v7 offset:50784
    ds_read_b64_tr_b16 a[184:185], v8 offset:96
    ds_read_b64_tr_b16 a[186:187], v8 offset:16992
    v_mfma_f32_16x16x32_bf16 v[100:103], a[32:35], v[64:67], v[100:103]
    ds_read_b64_tr_b16 a[188:189], v8 offset:33888
    ds_read_b64_tr_b16 a[190:191], v8 offset:50784
    ds_read_b64_tr_b16 a[192:193], v7 offset:128
    v_mfma_f32_16x16x32_bf16 v[104:107], a[96:99], v[64:67], v[104:107]
    ds_read_b64_tr_b16 a[194:195], v7 offset:17024
    ds_read_b64_tr_b16 a[196:197], v7 offset:33920
    ds_read_b64_tr_b16 a[198:199], v7 offset:50816
    buffer_load_dwordx4 v[192:195], v22, s[44:47], s71 offen
    s_add_u32 s71, s71, 4096
    v_mfma_f32_16x16x32_bf16 v[100:103], a[36:39], v[68:71], v[100:103]
    ds_read_b64_tr_b16 a[200:201], v8 offset:128
    ds_read_b64_tr_b16 a[202:203], v8 offset:17024
    ds_read_b64_tr_b16 a[204:205], v8 offset:33920
    v_mfma_f32_16x16x32_bf16 v[104:107], a[100:103], v[68:71], v[104:107]
    ds_read_b64_tr_b16 a[206:207], v8 offset:50816
    ds_read_b64_tr_b16 a[208:209], v7 offset:160
    ds_read_b64_tr_b16 a[210:211], v7 offset:17056
    v_mfma_f32_16x16x32_bf16 v[100:103], a[40:43], v[72:75], v[100:103]
    ds_read_b64_tr_b16 a[212:213], v7 offset:33952
    ds_read_b64_tr_b16 a[214:215], v7 offset:50848
    ds_read_b64_tr_b16 a[216:217], v8 offset:160
    v_mfma_f32_16x16x32_bf16 v[104:107], a[104:107], v[72:75], v[104:107]
    ds_read_b64_tr_b16 a[218:219], v8 offset:17056
    ds_read_b64_tr_b16 a[220:221], v8 offset:33952
    ds_read_b64_tr_b16 a[222:223], v8 offset:50848
    v_mfma_f32_16x16x32_bf16 v[100:103], a[44:47], v[76:79], v[100:103]
    ds_read_b64_tr_b16 a[224:225], v7 offset:192
    ds_read_b64_tr_b16 a[226:227], v7 offset:17088
    ds_read_b64_tr_b16 a[228:229], v7 offset:33984
    v_mfma_f32_16x16x32_bf16 v[104:107], a[108:111], v[76:79], v[104:107]
    ds_read_b64_tr_b16 a[230:231], v7 offset:50880
    ds_read_b64_tr_b16 a[232:233], v8 offset:192
    ds_read_b64_tr_b16 a[234:235], v8 offset:17088
    buffer_load_dwordx4 v[192:195], v22, s[44:47], s71 offen
    s_add_u32 s71, s71, 4096
    v_mfma_f32_16x16x32_bf16 v[100:103], a[48:51], v[80:83], v[100:103]
    ds_read_b64_tr_b16 a[236:237], v8 offset:33984
    ds_read_b64_tr_b16 a[238:239], v8 offset:50880
    ds_read_b64_tr_b16 a[240:241], v7 offset:224
    v_mfma_f32_16x16x32_bf16 v[104:107], a[112:115], v[80:83], v[104:107]
    ds_read_b64_tr_b16 a[242:243], v7 offset:17120
    ds_read_b64_tr_b16 a[244:245], v7 offset:34016
    ds_read_b64_tr_b16 a[246:247], v7 offset:50912
    v_mfma_f32_16x16x32_bf16 v[100:103], a[52:55], v[84:87], v[100:103]
    ds_read_b64_tr_b16 a[248:249], v8 offset:224
    ds_read_b64_tr_b16 a[250:251], v8 offset:17120
    ds_read_b64_tr_b16 a[252:253], v8 offset:34016
    v_mfma_f32_16x16x32_bf16 v[104:107], a[116:119], v[84:87], v[104:107]
    ds_read_b64_tr_b16 a[254:255], v8 offset:50912
    v_mfma_f32_16x16x32_bf16 v[100:103], a[56:59], v[88:91], v[100:103]
    v_mfma_f32_16x16x32_bf16 v[104:107], a[120:123], v[88:91], v[104:107]
    buffer_load_dwordx4 v[192:195], v22, s[44:47], s71 offen
    s_add_u32 s71, s71, 4096
    v_mfma_f32_16x16x32_bf16 v[100:103], a[60:63], v[92:95], v[100:103]
    v_mfma_f32_16x16x32_bf16 v[104:107], a[124:127], v[92:95], v[104:107]
    s_nop 6
    v_max3_f32 v108, v100, v101, v102
    v_max3_f32 v109, v103, v104, v105
    v_max3_f32 v108, v108, v106, v107
    v_max_f32 v108, v108, v109
    v_mov_b32 v109, v108
    s_nop 1
    v_permlane16_swap_b32 v108, v109
    v_max_f32 v108, v108, v109
    v_mov_b32 v109, v108
    s_nop 1
    v_permlane32_swap_b32 v108, v109
    v_max_f32 v108, v108, v109
    ds_write_b32 v27, v108
    s_waitcnt lgkmcnt(0)
    s_barrier
    ds_read_b128 v[108:111], v28
    s_waitcnt lgkmcnt(0)
    v_max3_f32 v108, v108, v109, v110
    v_max_f32 v108, v108, v111
    v_sub_f32 v100, v100, v108
    v_sub_f32 v101, v101, v108
    v_sub_f32 v102, v102, v108
    v_sub_f32 v103, v103, v108
    v_sub_f32 v104, v104, v108
    v_sub_f32 v105, v105, v108
    v_sub_f32 v106, v106, v108
    v_sub_f32 v107, v107, v108
    v_exp_f32 v100, v100
    v_exp_f32 v101, v101
    v_exp_f32 v102, v102
    v_exp_f32 v103, v103
    v_exp_f32 v104, v104
    v_exp_f32 v105, v105
    v_exp_f32 v106, v106
    v_exp_f32 v107, v107
    v_cvt_pk_bf16_f32 v112, v100, v101
    v_cvt_pk_bf16_f32 v113, v102, v103
    v_cvt_pk_bf16_f32 v114, v104, v105
    v_cvt_pk_bf16_f32 v115, v106, v107
    ds_write_b128 v29, v[112:115]
    s_waitcnt lgkmcnt(0)
    s_barrier
    ds_read_b128 v[32:35], v31 offset:0
    ds_read_b128 v[36:39], v31 offset:1024
    ds_read_b128 v[40:43], v31 offset:2048
    ds_read_b128 v[44:47], v31 offset:3072
    s_add_u32 s75, s73, 65536
    s_waitcnt lgkmcnt(0)
    v_mfma_f32_16x16x32_bf16 v[188:191], v[32:35], v[184:187], 0
    v_mfma_f32_16x16x32_bf16 v[188:191], v[36:39], v[184:187], v[188:191]
    v_mfma_f32_16x16x32_bf16 v[188:191], v[40:43], v[184:187], v[188:191]
    v_mfma_f32_16x16x32_bf16 v[188:191], v[44:47], v[184:187], v[188:191]
    v_mfma_f32_16x16x32_bf16 v[120:123], v[32:35], a[128:131], 0
    v_mfma_f32_16x16x32_bf16 v[120:123], v[36:39], a[132:135], v[120:123]
    v_mfma_f32_16x16x32_bf16 v[120:123], v[40:43], a[136:139], v[120:123]
    v_mfma_f32_16x16x32_bf16 v[120:123], v[44:47], a[140:143], v[120:123]
    buffer_load_dwordx4 v[192:195], v22, s[44:47], s71 offen
    s_add_u32 s71, s71, 4096
    v_mfma_f32_16x16x32_bf16 v[124:127], v[32:35], a[144:147], 0
    v_mfma_f32_16x16x32_bf16 v[124:127], v[36:39], a[148:151], v[124:127]
    v_mfma_f32_16x16x32_bf16 v[124:127], v[40:43], a[152:155], v[124:127]
    v_mfma_f32_16x16x32_bf16 v[124:127], v[44:47], a[156:159], v[124:127]
    v_mfma_f32_16x16x32_bf16 v[128:131], v[32:35], a[160:163], 0
    v_mfma_f32_16x16x32_bf16 v[128:131], v[36:39], a[164:167], v[128:131]
    buffer_load_dwordx4 v[192:195], v22, s[44:47], s71 offen
    s_add_u32 s71, s71, 4096
    v_mfma_f32_16x16x32_bf16 v[128:131], v[40:43], a[168:171], v[128:131]
    v_mfma_f32_16x16x32_bf16 v[128:131], v[44:47], a[172:175], v[128:131]
    v_mfma_f32_16x16x32_bf16 v[132:135], v[32:35], a[176:179], 0
    v_mfma_f32_16x16x32_bf16 v[132:135], v[36:39], a[180:183], v[132:135]
    v_mfma_f32_16x16x32_bf16 v[132:135], v[40:43], a[184:187], v[132:135]
    v_mfma_f32_16x16x32_bf16 v[132:135], v[44:47], a[188:191], v[132:135]
    buffer_load_dwordx4 v[192:195], v22, s[44:47], s71 offen
    s_add_u32 s71, s71, 4096
    v_mfma_f32_16x16x32_bf16 v[136:139], v[32:35], a[192:195], 0
    v_mfma_f32_16x16x32_bf16 v[136:139], v[36:39], a[196:199], v[136:139]
    s_cmp_eq_u32 s57, 0
    s_cbranch_scc0 L_Y_nostat
    v_cndmask_b32 v110, v188, v189, s[8:9]
    v_cndmask_b32 v111, v190, v191, s[8:9]
    v_cndmask_b32 v110, v110, v111, s[10:11]
    v_mov_b32 v109, s56
    v_mov_b32 v111, s56
    s_mov_b64 exec, 0x00f0000f
    buffer_store_dwordx4 v[108:111], v26, s[32:35], s72 offen sc1
    s_mov_b64 exec, -1
L_Y_nostat:
    v_mfma_f32_16x16x32_bf16 v[136:139], v[40:43], a[200:203], v[136:139]
    v_cndmask_b32 v120, v120, v122, s[12:13]
    v_cndmask_b32 v124, v124, v126, s[12:13]
    v_mfma_f32_16x16x32_bf16 v[136:139], v[44:47], a[204:207], v[136:139]
    v_cndmask_b32 v128, v128, v130, s[12:13]
    v_cndmask_b32 v132, v132, v134, s[12:13]
    v_mfma_f32_16x16x32_bf16 v[140:143], v[32:35], a[208:211], 0
    v_cvt_pk_bf16_f32 v160, v120, v124
    v_mov_b32 v161, s56
    v_mfma_f32_16x16x32_bf16 v[140:143], v[36:39], a[212:215], v[140:143]
    buffer_load_dwordx4 v[192:195], v22, s[44:47], s71 offen
    s_add_u32 s71, s71, 4096
    v_cvt_pk_bf16_f32 v162, v128, v132
    v_mov_b32 v163, s56
    v_mfma_f32_16x16x32_bf16 v[140:143], v[40:43], a[216:219], v[140:143]
    buffer_store_dwordx4 v[160:163], v30, s[32:35], s73 offen offset:0 sc1
    v_cndmask_b32 v121, v121, v123, s[12:13]
    v_mfma_f32_16x16x32_bf16 v[140:143], v[44:47], a[220:223], v[140:143]
    v_cndmask_b32 v125, v125, v127, s[12:13]
    v_cndmask_b32 v129, v129, v131, s[12:13]
    v_mfma_f32_16x16x32_bf16 v[144:147], v[32:35], a[224:227], 0
    v_cndmask_b32 v133, v133, v135, s[12:13]
    v_cvt_pk_bf16_f32 v164, v121, v125
    v_mfma_f32_16x16x32_bf16 v[144:147], v[36:39], a[228:231], v[144:147]
    v_mov_b32 v165, s56
    v_cvt_pk_bf16_f32 v166, v129, v133
    v_mfma_f32_16x16x32_bf16 v[144:147], v[40:43], a[232:235], v[144:147]
    v_mov_b32 v167, s56
    buffer_store_dwordx4 v[164:167], v30, s[32:35], s75 offen offset:0 sc1
    v_mfma_f32_16x16x32_bf16 v[144:147], v[44:47], a[236:239], v[144:147]
    buffer_load_dwordx4 v[192:195], v22, s[44:47], s71 offen
    s_add_u32 s71, s71, 4096
    v_mfma_f32_16x16x32_bf16 v[148:151], v[32:35], a[240:243], 0
    v_mfma_f32_16x16x32_bf16 v[148:151], v[36:39], a[244:247], v[148:151]
    v_mfma_f32_16x16x32_bf16 v[148:151], v[40:43], a[248:251], v[148:151]
    v_mfma_f32_16x16x32_bf16 v[148:151], v[44:47], a[252:255], v[148:151]
    v_cndmask_b32 v136, v136, v138, s[12:13]
    v_cndmask_b32 v140, v140, v142, s[12:13]
    v_cndmask_b32 v144, v144, v146, s[12:13]
    s_nop 4
    v_cndmask_b32 v148, v148, v150, s[12:13]
    v_cvt_pk_bf16_f32 v168, v136, v140
    v_mov_b32 v169, s56
    v_cvt_pk_bf16_f32 v170, v144, v148
    v_mov_b32 v171, s56
    buffer_store_dwordx4 v[168:171], v30, s[32:35], s73 offen offset:256 sc1
    v_cndmask_b32 v137, v137, v139, s[12:13]
    v_cndmask_b32 v141, v141, v143, s[12:13]
    v_cndmask_b32 v145, v145, v147, s[12:13]
    v_cndmask_b32 v149, v149, v151, s[12:13]
    v_cvt_pk_bf16_f32 v172, v137, v141
    v_mov_b32 v173, s56
    v_cvt_pk_bf16_f32 v174, v145, v149
    v_mov_b32 v175, s56
    buffer_store_dwordx4 v[172:175], v30, s[32:35], s75 offen offset:256 sc1
    s_add_u32 s65, s74, 16
    s_waitcnt vmcnt(2)
    v_lshrrev_b32 v9, 2, v1
    v_mul_u32_u24 v9, 1280, v9
    v_bfe_u32 v10, v1, 4, 1
    v_lshlrev_b32 v10, 1, v10
    v_and_b32 v11, 3, v1
    v_xor_b32 v10, v10, v11
    v_lshl_add_u32 v9, v10, 4, v9
    s_and_b32 s62, s2, 7
    s_lshl_b32 s62, s62, 2
    s_add_u32 s62, s62, s57
    s_mul_i32 s62, s62, 163840
    s_lshl_b32 s63, s74, 6
    s_add_u32 s62, s62, s63
    s_lshl_b32 s63, s57, 13
    s_add_u32 s63, s63, 0
    s_mov_b32 m0, s63
    s_add_u32 s63, s63, 1024
    buffer_load_dwordx4 v9, s[44:47], s62 offen lds
    s_add_u32 s62, s62, 20480
    s_mov_b32 m0, s63
    s_add_u32 s63, s63, 1024
    buffer_load_dwordx4 v9, s[44:47], s62 offen lds
    s_add_u32 s62, s62, 20480
    s_mov_b32 m0, s63
    s_add_u32 s63, s63, 1024
    buffer_load_dwordx4 v9, s[44:47], s62 offen lds
    s_add_u32 s62, s62, 20480
    s_mov_b32 m0, s63
    s_add_u32 s63, s63, 1024
    buffer_load_dwordx4 v9, s[44:47], s62 offen lds
    s_add_u32 s62, s62, 20480
    s_mov_b32 m0, s63
    s_add_u32 s63, s63, 1024
    buffer_load_dwordx4 v9, s[44:47], s62 offen lds
    s_add_u32 s62, s62, 20480
    s_mov_b32 m0, s63
    s_add_u32 s63, s63, 1024
    buffer_load_dwordx4 v9, s[44:47], s62 offen lds
    s_add_u32 s62, s62, 20480
    s_mov_b32 m0, s63
    s_add_u32 s63, s63, 1024
    buffer_load_dwordx4 v9, s[44:47], s62 offen lds
    s_add_u32 s62, s62, 20480
    s_mov_b32 m0, s63
    s_add_u32 s63, s63, 1024
    buffer_load_dwordx4 v9, s[44:47], s62 offen lds
    s_cmp_lt_u32 s74, 4
    s_cbranch_scc0 L_Y_one
    v_lshrrev_b32 v9, 2, v1
    v_mul_u32_u24 v9, 1280, v9
    v_bfe_u32 v10, v1, 4, 1
    v_lshlrev_b32 v10, 1, v10
    v_and_b32 v11, 3, v1
    v_xor_b32 v10, v10, v11
    v_lshl_add_u32 v9, v10, 4, v9
    s_and_b32 s62, s2, 7
    s_lshl_b32 s62, s62, 2
    s_add_u32 s62, s62, s57
    s_mul_i32 s62, s62, 163840
    s_lshl_b32 s63, s65, 6
    s_add_u32 s62, s62, s63
    s_lshl_b32 s63, s57, 13
    s_add_u32 s63, s63, 32768
    s_mov_b32 m0, s63
    s_add_u32 s63, s63, 1024
    buffer_load_dwordx4 v9, s[44:47], s62 offen lds
    s_add_u32 s62, s62, 20480
    s_mov_b32 m0, s63
    s_add_u32 s63, s63, 1024
    buffer_load_dwordx4 v9, s[44:47], s62 offen lds
    s_add_u32 s62, s62, 20480
    s_mov_b32 m0, s63
    s_add_u32 s63, s63, 1024
    buffer_load_dwordx4 v9, s[44:47], s62 offen lds
    s_add_u32 s62, s62, 20480
    s_mov_b32 m0, s63
    s_add_u32 s63, s63, 1024
    buffer_load_dwordx4 v9, s[44:47], s62 offen lds
    s_add_u32 s62, s62, 20480
    s_mov_b32 m0, s63
    s_add_u32 s63, s63, 1024
    buffer_load_dwordx4 v9, s[44:47], s62 offen lds
    s_add_u32 s62, s62, 20480
    s_mov_b32 m0, s63
    s_add_u32 s63, s63, 1024
    buffer_load_dwordx4 v9, s[44:47], s62 offen lds
    s_add_u32 s62, s62, 20480
    s_mov_b32 m0, s63
    s_add_u32 s63, s63, 1024
    buffer_load_dwordx4 v9, s[44:47], s62 offen lds
    s_add_u32 s62, s62, 20480
    s_mov_b32 m0, s63
    s_add_u32 s63, s63, 1024
    buffer_load_dwordx4 v9, s[44:47], s62 offen lds
L_Y_one:
    v_lshlrev_b32 v17, 2, v0
    s_mov_b32 s52, s18
    s_mov_b32 s53, s19
    s_mov_b32 s54, 3456
    s_mov_b32 s55, 0x00020000
    buffer_load_dword v196, v17, s[52:55], 0 offen offset:0
    buffer_load_dword v197, v17, s[52:55], 0 offen offset:1024
    buffer_load_dword v198, v17, s[52:55], 0 offen offset:2048
    buffer_load_dword v199, v17, s[52:55], 0 offen offset:3072
    s_mov_b32 s52, s20
    s_mov_b32 s53, s21
    s_mov_b32 s54, 3456
    s_mov_b32 s55, 0x00020000
    buffer_load_dword v200, v17, s[52:55], 0 offen offset:0
    buffer_load_dword v201, v17, s[52:55], 0 offen offset:1024
    buffer_load_dword v202, v17, s[52:55], 0 offen offset:2048
    buffer_load_dword v203, v17, s[52:55], 0 offen offset:3072
    s_mov_b32 s52, s22
    s_mov_b32 s53, s23
    s_mov_b32 s54, 3456
    s_mov_b32 s55, 0x00020000
    buffer_load_dword v204, v17, s[52:55], 0 offen offset:0
    buffer_load_dword v205, v17, s[52:55], 0 offen offset:1024
    buffer_load_dword v206, v17, s[52:55], 0 offen offset:2048
    buffer_load_dword v207, v17, s[52:55], 0 offen offset:3072
    s_mov_b32 s52, s24
    s_mov_b32 s53, s25
    s_mov_b32 s54, 2
    s_mov_b32 s55, 0x00020000
    buffer_load_ushort v208, v18, s[52:55], 0 offen
    v_lshlrev_b32 v245, 3, v0
    buffer_load_dwordx2 v[246:247], v245, s[36:39], 0 offen
    s_and_b32 s62, s2, 7
    s_lshl_b32 s62, s62, 7
    s_add_u32 s62, s62, 1191936
    v_lshlrev_b32 v249, 2, v1
    v_and_b32 v249, 127, v249
    buffer_load_dword v252, v249, s[32:35], s62 offen nt
    v_lshlrev_b32 v240, 4, v1
    v_lshrrev_b32 v236, 5, v1
    v_lshlrev_b32 v236, 8, v236
    v_bfe_u32 v235, v1, 2, 2
    v_lshl_add_u32 v236, v235, 6, v236
    v_and_b32 v235, 3, v1
    v_lshl_add_u32 v236, v235, 4, v236
    v_bfe_u32 v235, v1, 4, 1
    v_lshl_add_u32 v236, v235, 3, v236
    s_lshl_b32 s62, s57, 10
    s_add_u32 s62, s62, 65536
    v_add_u32 v236, s62, v236
    v_and_b32 v235, 3, v3
    v_lshlrev_b32 v235, 4, v235
    v_lshl_add_u32 v235, v4, 6, v235
    v_add_u32 v235, s62, v235
    s_and_b32 s62, s2, 7
    s_lshl_b32 s63, s62, 2
    s_add_u32 s63, s63, s57
    s_lshl_b32 s63, s63, 11
    s_add_u32 s101, s63, 217088
    s_mul_i32 s63, s62, 2560
    s_lshl_b32 s65, s74, 7
    s_add_u32 s63, s63, s65
    s_add_u32 s63, s63, 1171456
    v_lshlrev_b32 v243, 2, v1
    v_add_u32 v243, s63, v243
    s_lshl_b32 s62, s62, 7
    s_lshl_b32 s63, s74, 2
    s_add_u32 s62, s62, s63
    s_add_u32 s62, s62, 1191936
    v_mov_b32 v244, s62
    v_lshlrev_b32 v241, 2, v1
    v_add_u32 v242, 146176, v241
    s_lshl_b32 s62, s57, 7
    v_add_u32 v241, s62, v242
    v_lshlrev_b32 v253, 7, v3
    buffer_load_dword v252, v253, s[32:35], s101 offen nt
    s_waitcnt vmcnt(0)
    v_lshrrev_b32 v9, 2, v3
    v_lshl_add_u32 v9, v4, 2, v9
    v_lshlrev_b32 v9, 6, v9
    v_and_b32 v10, 1, v4
    v_lshl_add_u32 v9, v10, 5, v9
    v_and_b32 v10, 3, v3
    v_lshl_add_u32 v9, v10, 3, v9
    s_lshl_b32 s62, s57, 13
    v_add_u32 v9, s62, v9
    v_xor_b32 v10, 32, v9
    ds_read_b64_tr_b16 a[0:1], v9 offset:0
    ds_read_b64_tr_b16 a[2:3], v9 offset:1024
    ds_read_b64_tr_b16 a[4:5], v9 offset:2048
    ds_read_b64_tr_b16 a[6:7], v9 offset:3072
    ds_read_b64_tr_b16 a[8:9], v9 offset:4096
    ds_read_b64_tr_b16 a[10:11], v9 offset:5120
    ds_read_b64_tr_b16 a[12:13], v9 offset:6144
    ds_read_b64_tr_b16 a[14:15], v9 offset:7168
    ds_read_b64_tr_b16 a[16:17], v10 offset:0
    ds_read_b64_tr_b16 a[18:19], v10 offset:1024
    ds_read_b64_tr_b16 a[20:21], v10 offset:2048
    ds_read_b64_tr_b16 a[22:23], v10 offset:3072
    ds_read_b64_tr_b16 a[24:25], v10 offset:4096
    ds_read_b64_tr_b16 a[26:27], v10 offset:5120
    ds_read_b64_tr_b16 a[28:29], v10 offset:6144
    ds_read_b64_tr_b16 a[30:31], v10 offset:7168
    s_cmp_lt_u32 s74, 4
    s_cbranch_scc0 L_Y_one2
    v_lshrrev_b32 v9, 2, v3
    v_lshl_add_u32 v9, v4, 2, v9
    v_lshlrev_b32 v9, 6, v9
    v_and_b32 v10, 1, v4
    v_lshl_add_u32 v9, v10, 5, v9
    v_and_b32 v10, 3, v3
    v_lshl_add_u32 v9, v10, 3, v9
    s_lshl_b32 s62, s57, 13
    v_add_u32 v9, s62, v9
    v_xor_b32 v10, 32, v9
    ds_read_b64_tr_b16 a[32:33], v9 offset:32768
    ds_read_b64_tr_b16 a[34:35], v9 offset:33792
    ds_read_b64_tr_b16 a[36:37], v9 offset:34816
    ds_read_b64_tr_b16 a[38:39], v9 offset:35840
    ds_read_b64_tr_b16 a[40:41], v9 offset:36864
    ds_read_b64_tr_b16 a[42:43], v9 offset:37888
    ds_read_b64_tr_b16 a[44:45], v9 offset:38912
    ds_read_b64_tr_b16 a[46:47], v9 offset:39936
    ds_read_b64_tr_b16 a[48:49], v10 offset:32768
    ds_read_b64_tr_b16 a[50:51], v10 offset:33792
    ds_read_b64_tr_b16 a[52:53], v10 offset:34816
    ds_read_b64_tr_b16 a[54:55], v10 offset:35840
    ds_read_b64_tr_b16 a[56:57], v10 offset:36864
    ds_read_b64_tr_b16 a[58:59], v10 offset:37888
    ds_read_b64_tr_b16 a[60:61], v10 offset:38912
    ds_read_b64_tr_b16 a[62:63], v10 offset:39936
L_Y_one2:
    s_mov_b32 s63, 0xffff0000
    v_lshlrev_b32 v210, 16, v196
    v_and_b32 v211, s63, v196
    v_lshlrev_b32 v212, 16, v197
    v_and_b32 v213, s63, v197
    v_lshlrev_b32 v214, 16, v198
    v_and_b32 v215, s63, v198
    v_lshlrev_b32 v216, 16, v199
    v_and_b32 v217, s63, v199
    v_lshlrev_b32 v218, 16, v200
    v_and_b32 v219, s63, v200
    v_lshlrev_b32 v220, 16, v201
    v_and_b32 v221, s63, v201
    v_lshlrev_b32 v222, 16, v202
    v_and_b32 v223, s63, v202
    v_lshlrev_b32 v224, 16, v203
    v_and_b32 v225, s63, v203
    v_lshlrev_b32 v226, 16, v204
    v_and_b32 v227, s63, v204
    v_lshlrev_b32 v228, 16, v205
    v_and_b32 v229, s63, v205
    v_lshlrev_b32 v230, 16, v206
    v_and_b32 v231, s63, v206
    v_lshlrev_b32 v232, 16, v207
    v_and_b32 v233, s63, v207
    v_lshlrev_b32 v208, 16, v208
    s_add_u32 s68, s101, 233472
    s_waitcnt lgkmcnt(0)
    s_mov_b32 s61, 0
L_p4:
    s_and_b32 s75, s61, 31
    s_cmp_eq_u32 s75, 31
    s_cselect_b32 s66, s68, s101
    s_cmp_eq_u32 s75, 31
    s_cbranch_scc1 L_p4_b
    buffer_load_dwordx4 v[140:143], v240, s[32:35], s66 offen nt
    buffer_load_dwordx4 v[144:147], v240, s[32:35], s66 offen offset:1024 nt
    s_branch L_p4_c
L_p4_b:
    buffer_load_dwordx4 v[140:143], v240, s[32:35], s66 offen sc1
    buffer_load_dwordx4 v[144:147], v240, s[32:35], s66 offen offset:1024 sc1
L_p4_c:
    s_waitcnt vmcnt(0)
    v_xor_b32 v14, s56, v141
    v_bitop3_b32 v14, v143, s56, v14 bitop3:0xbe
    v_bitop3_b32 v14, v145, s56, v14 bitop3:0xbe
    v_bitop3_b32 v14, v147, s56, v14 bitop3:0xbe
    v_cmp_ne_u32 vcc, 0, v14
    s_add_u32 s61, s61, 1
    s_cbranch_vccz L_p4_x
    s_cmp_gt_u32 s61, 400000
    s_cbranch_scc1 L_p4_x
    s_and_b64 exec, exec, vcc
    s_branch L_p4
L_p4_x:
    s_mov_b64 exec, -1
    v_mov_b32 v141, v142
    v_mov_b32 v145, v146
    ds_write_b64 v236, v[140:141]
    ds_write_b64 v236, v[144:145] offset:512
    ds_read_b128 v[100:103], v235 offset:0
    ds_read_b128 v[108:111], v235 offset:256
    ds_read_b128 v[116:119], v235 offset:512
    ds_read_b128 v[124:127], v235 offset:768
    s_waitcnt lgkmcnt(0)
    v_cmp_eq_u32 vcc, 1, v4
    v_mfma_f32_16x16x32_bf16 v[156:159], v[100:103], a[0:3], 0
    v_mfma_f32_16x16x32_bf16 v[160:163], v[100:103], a[16:19], 0
    v_mfma_f32_16x16x32_bf16 v[156:159], v[108:111], a[4:7], v[156:159]
    v_mfma_f32_16x16x32_bf16 v[160:163], v[108:111], a[20:23], v[160:163]
    v_mfma_f32_16x16x32_bf16 v[156:159], v[116:119], a[8:11], v[156:159]
    v_mfma_f32_16x16x32_bf16 v[160:163], v[116:119], a[24:27], v[160:163]
    v_mfma_f32_16x16x32_bf16 v[156:159], v[124:127], a[12:15], v[156:159]
    v_mfma_f32_16x16x32_bf16 v[160:163], v[124:127], a[28:31], v[160:163]
    s_nop 6
    v_pk_add_f32 v[156:157], v[156:157], v[158:159]
    v_pk_add_f32 v[160:161], v[160:161], v[162:163]
    v_add_f32 v156, v156, v157
    v_add_f32 v160, v160, v161
    v_cndmask_b32 v156, v156, v160, vcc
    s_mov_b32 exec_hi, 0
    ds_write_b32 v241, v156 offset:0
    s_mov_b64 exec, -1
    s_cmp_lt_u32 s74, 4
    s_cbranch_scc0 L_Y_one3
    v_mfma_f32_16x16x32_bf16 v[148:151], v[100:103], a[32:35], 0
    v_mfma_f32_16x16x32_bf16 v[152:155], v[100:103], a[48:51], 0
    v_mfma_f32_16x16x32_bf16 v[148:151], v[108:111], a[36:39], v[148:151]
    v_mfma_f32_16x16x32_bf16 v[152:155], v[108:111], a[52:55], v[152:155]
    v_mfma_f32_16x16x32_bf16 v[148:151], v[116:119], a[40:43], v[148:151]
    v_mfma_f32_16x16x32_bf16 v[152:155], v[116:119], a[56:59], v[152:155]
    v_mfma_f32_16x16x32_bf16 v[148:151], v[124:127], a[44:47], v[148:151]
    v_mfma_f32_16x16x32_bf16 v[152:155], v[124:127], a[60:63], v[152:155]
    s_nop 6
    v_pk_add_f32 v[148:149], v[148:149], v[150:151]
    v_pk_add_f32 v[152:153], v[152:153], v[154:155]
    v_add_f32 v148, v148, v149
    v_add_f32 v152, v152, v153
    v_cndmask_b32 v148, v148, v152, vcc
    s_mov_b32 exec_hi, 0
    ds_write_b32 v241, v148 offset:512
    s_mov_b64 exec, -1
L_Y_one3:
    s_waitcnt lgkmcnt(0)
    s_barrier
    s_cmp_eq_u32 s57, 0
    s_cbranch_scc1 L_Y_pub
    s_cmp_eq_u32 s57, 1
    s_cbranch_scc0 L_M
    s_cmp_lt_u32 s74, 4
    s_cbranch_scc0 L_M
    v_add_u32 v242, 512, v242
    v_add_u32 v243, 2048, v243
    v_add_u32 v244, 64, v244
L_Y_pub:
    ds_read_b32 v136, v242
    ds_read_b32 v137, v242 offset:128
    ds_read_b32 v138, v242 offset:256
    ds_read_b32 v139, v242 offset:384
    s_waitcnt lgkmcnt(0)
    v_pk_add_f32 v[136:137], v[136:137], v[138:139]
    v_add_f32 v136, v136, v137
    s_nop 1
    v_mov_b32_dpp v137, v136 row_shl:1 row_mask:0xf bank_mask:0xf
    v_cvt_pk_bf16_f32 v138, v136, v137
    v_mov_b32 v139, s56
    s_mov_b32 exec_lo, 0x55555555
    s_mov_b32 exec_hi, 0
    buffer_store_dwordx2 v[138:139], v243, s[32:35], 0 offen sc1
    s_mov_b64 exec, 1
    buffer_store_dword v139, v244, s[32:35], 0 offen
    s_mov_b64 exec, -1
L_M:
    s_mul_i32 s64, s2, 3
    s_cmp_ge_u32 s64, 640
    s_cbranch_scc1 L_fin
    v_mov_b32 v144, 0xc0135761
    v_mov_b32 v145, 0xc0135761
    v_mov_b32 v146, 0
    v_mov_b32 v147, 0
    v_mov_b32 v148, 0
    v_mov_b32 v149, 0
    v_mov_b32 v150, 0
    v_mov_b32 v151, 0
    v_add_u32 v15, s64, v1
    v_min_u32 v15, 639, v15
    v_lshlrev_b32 v15, 2, v15
    v_add_u32 v15, 143616, v15
    v_mov_b32 v132, 0
    v_mov_b32 v133, 0
    s_cmp_eq_u32 s57, 3
    s_cbranch_scc1 L_M_wait
    v_lshlrev_b32 v13, 4, v0
    s_mov_b32 s66, 1171456
    s_mov_b32 s67, 1176576
    s_mov_b32 s68, 1181696
    s_mov_b32 s69, 1186816
    s_mov_b32 s63, 0xffff0000
    v_lshlrev_b32 v136, 16, v246
    v_and_b32 v137, s63, v246
    v_lshlrev_b32 v138, 16, v247
    v_and_b32 v139, s63, v247
    v_add_u32 v17, 143616, v13
    s_lshl_b32 s62, s57, 3
    s_add_u32 s62, s62, 148288
    v_mov_b32 v19, s62
    s_cmp_eq_u32 s57, 2
    s_cselect_b32 s72, 0, -1
    s_mov_b32 exec_hi, s72
    s_mov_b64 s[98:99], exec
    s_mov_b64 exec, 0xfffff
    s_and_b32 s62, s2, 7
    s_lshl_b32 s62, s62, 7
    s_add_u32 s62, s62, 1191936
    v_lshlrev_b32 v14, 2, v1
    v_mov_b32 v16, v14
    s_mov_b32 s61, 0
L_g6:
    buffer_load_dword v100, v16, s[32:35], s62 offen nt
    s_waitcnt vmcnt(0)
    v_cmp_ne_u32 vcc, s56, v100
    s_add_u32 s61, s61, 1
    s_cmp_gt_u32 s61, 64
    s_cbranch_scc1 L_g6x
    s_cbranch_vccnz L_g6
L_g6x:
    s_mov_b64 exec, s[98:99]
    s_mov_b32 s61, 0
L_p6:
    buffer_load_dwordx4 v[100:103], v13, s[32:35], s66 offen offset:0 sc1
    buffer_load_dwordx4 v[104:107], v13, s[32:35], s66 offen offset:2560 sc1
    buffer_load_dwordx4 v[108:111], v13, s[32:35], s67 offen offset:0 sc1
    buffer_load_dwordx4 v[112:115], v13, s[32:35], s67 offen offset:2560 sc1
    buffer_load_dwordx4 v[116:119], v13, s[32:35], s68 offen offset:0 sc1
    buffer_load_dwordx4 v[120:123], v13, s[32:35], s68 offen offset:2560 sc1
    buffer_load_dwordx4 v[124:127], v13, s[32:35], s69 offen offset:0 sc1
    buffer_load_dwordx4 v[128:131], v13, s[32:35], s69 offen offset:2560 sc1
    s_waitcnt vmcnt(0)
    v_xor_b32 v14, s56, v101
    v_bitop3_b32 v14, v103, s56, v14 bitop3:0xbe
    v_bitop3_b32 v14, v105, s56, v14 bitop3:0xbe
    v_bitop3_b32 v14, v107, s56, v14 bitop3:0xbe
    v_bitop3_b32 v14, v109, s56, v14 bitop3:0xbe
    v_bitop3_b32 v14, v111, s56, v14 bitop3:0xbe
    v_bitop3_b32 v14, v113, s56, v14 bitop3:0xbe
    v_bitop3_b32 v14, v115, s56, v14 bitop3:0xbe
    v_bitop3_b32 v14, v117, s56, v14 bitop3:0xbe
    v_bitop3_b32 v14, v119, s56, v14 bitop3:0xbe
    v_bitop3_b32 v14, v121, s56, v14 bitop3:0xbe
    v_bitop3_b32 v14, v123, s56, v14 bitop3:0xbe
    v_bitop3_b32 v14, v125, s56, v14 bitop3:0xbe
    v_bitop3_b32 v14, v127, s56, v14 bitop3:0xbe
    v_bitop3_b32 v14, v129, s56, v14 bitop3:0xbe
    v_bitop3_b32 v14, v131, s56, v14 bitop3:0xbe
    v_cmp_ne_u32 vcc, 0, v14
    s_add_u32 s61, s61, 1
    s_cbranch_vccz L_p6_x
    s_cmp_gt_u32 s61, 400000
    s_cbranch_scc1 L_p6_x
    s_and_b64 exec, exec, vcc
    s_branch L_p6
L_p6_x:
    s_mov_b64 exec, -1
    s_mov_b32 exec_hi, s72
    v_lshlrev_b32 v136, 16, v246
    v_and_b32 v137, s63, v246
    v_lshlrev_b32 v138, 16, v247
    v_and_b32 v139, s63, v247
    v_lshlrev_b32 v140, 16, v100
    v_and_b32 v141, s63, v100
    v_lshlrev_b32 v142, 16, v102
    v_and_b32 v143, s63, v102
    v_pk_add_f32 v[136:137], v[136:137], v[140:141]
    v_pk_add_f32 v[138:139], v[138:139], v[142:143]
    v_lshlrev_b32 v140, 16, v104
    v_and_b32 v141, s63, v104
    v_lshlrev_b32 v142, 16, v106
    v_and_b32 v143, s63, v106
    v_pk_add_f32 v[136:137], v[136:137], v[140:141]
    v_pk_add_f32 v[138:139], v[138:139], v[142:143]
    v_lshlrev_b32 v140, 16, v108
    v_and_b32 v141, s63, v108
    v_lshlrev_b32 v142, 16, v110
    v_and_b32 v143, s63, v110
    v_pk_add_f32 v[136:137], v[136:137], v[140:141]
    v_pk_add_f32 v[138:139], v[138:139], v[142:143]
    v_lshlrev_b32 v140, 16, v112
    v_and_b32 v141, s63, v112
    v_lshlrev_b32 v142, 16, v114
    v_and_b32 v143, s63, v114
    v_pk_add_f32 v[136:137], v[136:137], v[140:141]
    v_pk_add_f32 v[138:139], v[138:139], v[142:143]
    v_lshlrev_b32 v140, 16, v116
    v_and_b32 v141, s63, v116
    v_lshlrev_b32 v142, 16, v118
    v_and_b32 v143, s63, v118
    v_pk_add_f32 v[136:137], v[136:137], v[140:141]
    v_pk_add_f32 v[138:139], v[138:139], v[142:143]
    v_lshlrev_b32 v140, 16, v120
    v_and_b32 v141, s63, v120
    v_lshlrev_b32 v142, 16, v122
    v_and_b32 v143, s63, v122
    v_pk_add_f32 v[136:137], v[136:137], v[140:141]
    v_pk_add_f32 v[138:139], v[138:139], v[142:143]
    v_lshlrev_b32 v140, 16, v124
    v_and_b32 v141, s63, v124
    v_lshlrev_b32 v142, 16, v126
    v_and_b32 v143, s63, v126
    v_pk_add_f32 v[136:137], v[136:137], v[140:141]
    v_pk_add_f32 v[138:139], v[138:139], v[142:143]
    v_lshlrev_b32 v140, 16, v128
    v_and_b32 v141, s63, v128
    v_lshlrev_b32 v142, 16, v130
    v_and_b32 v143, s63, v130
    v_pk_add_f32 v[136:137], v[136:137], v[140:141]
    v_pk_add_f32 v[138:139], v[138:139], v[142:143]
L_M_sum:
    v_cvt_pk_bf16_f32 v140, v136, v137
    v_cvt_pk_bf16_f32 v141, v138, v139
    v_lshlrev_b32 v136, 16, v140
    v_and_b32 v137, s63, v140
    v_lshlrev_b32 v138, 16, v141
    v_and_b32 v139, s63, v141
    ds_write_b128 v17, v[136:139]
    v_subrev_f32 v140, s3, v136
    v_subrev_f32 v141, s3, v137
    v_subrev_f32 v142, s3, v138
    v_subrev_f32 v143, s3, v139
    v_add_f32 v132, v140, v141
    v_mul_f32 v133, v140, v140
    v_add_f32 v134, v142, v143
    v_fmac_f32 v133, v141, v141
    v_add_f32 v132, v132, v134
    v_fmac_f32 v133, v142, v142
    v_fmac_f32 v133, v143, v143
    s_mov_b64 exec, -1
    s_nop 0
    v_add_f32_dpp v132, v132, v132 quad_perm:[1,0,3,2] row_mask:0xf bank_mask:0xf
    v_add_f32_dpp v133, v133, v133 quad_perm:[1,0,3,2] row_mask:0xf bank_mask:0xf
    s_nop 0
    v_add_f32_dpp v132, v132, v132 quad_perm:[2,3,0,1] row_mask:0xf bank_mask:0xf
    v_add_f32_dpp v133, v133, v133 quad_perm:[2,3,0,1] row_mask:0xf bank_mask:0xf
    s_nop 0
    v_add_f32_dpp v132, v132, v132 row_half_mirror row_mask:0xf bank_mask:0xf
    v_add_f32_dpp v133, v133, v133 row_half_mirror row_mask:0xf bank_mask:0xf
    s_nop 0
    v_add_f32_dpp v132, v132, v132 row_mirror row_mask:0xf bank_mask:0xf
    v_add_f32_dpp v133, v133, v133 row_mirror row_mask:0xf bank_mask:0xf
    v_mov_b32 v134, v132
    v_mov_b32 v135, v133
    s_nop 0
    v_permlane16_swap_b32 v132, v134
    v_permlane16_swap_b32 v133, v135
    v_add_f32 v132, v132, v134
    v_add_f32 v133, v133, v135
    v_mov_b32 v134, v132
    v_mov_b32 v135, v133
    s_nop 0
    v_permlane32_swap_b32 v132, v134
    v_permlane32_swap_b32 v133, v135
    v_add_f32 v132, v132, v134
    v_add_f32 v133, v133, v135
    s_mov_b64 exec, 1
    ds_write_b64 v19, v[132:133]
    s_mov_b64 exec, -1
    s_or_b32 s62, s2, s57
    s_cmp_eq_u32 s62, 0
    s_cbranch_scc0 L_noep
    v_mov_b32 v16, s56
    s_mov_b64 exec, 1
    buffer_store_dword v16, v18, s[32:35], 0 offen sc1
    s_mov_b64 exec, -1
L_noep:
    s_waitcnt lgkmcnt(0)
L_M_wait:
    s_barrier
    v_mov_b32 v16, 148288
    ds_read_b128 v[120:123], v16
    ds_read_b64 v[124:125], v16 offset:16
    ds_read_b32 v136, v15
    s_mov_b32 s62, 0x3acccccd
    s_waitcnt lgkmcnt(0)
    v_add_f32 v130, v120, v122
    v_add_f32 v132, v121, v123
    v_add_f32 v130, v130, v124
    v_add_f32 v132, v132, v125
    v_mul_f32 v130, s62, v130
    v_mul_f32 v132, s62, v132
    v_fma_f32 v132, -v130, v130, v132
    v_add_f32 v130, s3, v130
    v_add_f32 v133, 0x3727c5ac, v132
    v_rsq_f32 v133, v133
    v_sub_f32 v140, v136, v130
    v_mul_f32 v134, v133, v133
    v_mul_f32 v134, v134, v132
    v_add_f32 v134, 0x3727c5ac, v134
    v_rsq_f32 v134, v134
    v_mul_f32 v140, v140, v133
    s_mov_b32 s62, 0xbdd2d3e8
    v_mul_f32 v140, v140, v134
    s_nop 0
    v_readlane_b32 s70, v140, 0
    v_readlane_b32 s72, v140, 1
    v_readlane_b32 s74, v140, 2
    v_pk_fma_f32 v[152:153], v[210:211], s[70:71], v[218:219] op_sel_hi:[1,0,1]
    v_pk_fma_f32 v[154:155], v[212:213], s[70:71], v[220:221] op_sel_hi:[1,0,1]
    v_pk_fma_f32 v[156:157], v[214:215], s[70:71], v[222:223] op_sel_hi:[1,0,1]
    v_pk_fma_f32 v[158:159], v[216:217], s[70:71], v[224:225] op_sel_hi:[1,0,1]
    v_pk_mul_f32 v[160:161], v[152:153], v[152:153]
    v_pk_mul_f32 v[162:163], v[154:155], v[154:155]
    v_pk_mul_f32 v[164:165], v[156:157], v[156:157]
    v_pk_mul_f32 v[166:167], v[158:159], v[158:159]
    v_pk_fma_f32 v[160:161], v[160:161], s[62:63], v[144:145] op_sel_hi:[1,0,1]
    v_pk_fma_f32 v[162:163], v[162:163], s[62:63], v[144:145] op_sel_hi:[1,0,1]
    v_pk_fma_f32 v[164:165], v[164:165], s[62:63], v[144:145] op_sel_hi:[1,0,1]
    v_pk_fma_f32 v[166:167], v[166:167], s[62:63], v[144:145] op_sel_hi:[1,0,1]
    v_pk_mul_f32 v[160:161], v[160:161], v[152:153]
    v_pk_mul_f32 v[162:163], v[162:163], v[154:155]
    v_pk_mul_f32 v[164:165], v[164:165], v[156:157]
    v_pk_mul_f32 v[166:167], v[166:167], v[158:159]
    v_exp_f32 v160, v160
    v_exp_f32 v161, v161
    v_exp_f32 v162, v162
    v_exp_f32 v163, v163
    v_exp_f32 v164, v164
    v_exp_f32 v165, v165
    v_exp_f32 v166, v166
    v_exp_f32 v167, v167
    v_pk_mul_f32 v[152:153], v[152:153], v[226:227]
    v_pk_mul_f32 v[154:155], v[154:155], v[228:229]
    v_pk_mul_f32 v[156:157], v[156:157], v[230:231]
    v_pk_mul_f32 v[158:159], v[158:159], v[232:233]
    v_pk_add_f32 v[160:161], v[160:161], 1.0 op_sel_hi:[1,0]
    v_pk_add_f32 v[162:163], v[162:163], 1.0 op_sel_hi:[1,0]
    v_pk_add_f32 v[164:165], v[164:165], 1.0 op_sel_hi:[1,0]
    v_pk_add_f32 v[166:167], v[166:167], 1.0 op_sel_hi:[1,0]
    v_rcp_f32 v160, v160
    v_rcp_f32 v161, v161
    v_rcp_f32 v162, v162
    v_rcp_f32 v163, v163
    v_rcp_f32 v164, v164
    v_rcp_f32 v165, v165
    v_rcp_f32 v166, v166
    v_rcp_f32 v167, v167
    v_pk_fma_f32 v[146:147], v[152:153], v[160:161], v[146:147]
    v_pk_fma_f32 v[146:147], v[154:155], v[162:163], v[146:147]
    v_pk_fma_f32 v[146:147], v[156:157], v[164:165], v[146:147]
    v_pk_fma_f32 v[146:147], v[158:159], v[166:167], v[146:147]
    v_pk_fma_f32 v[152:153], v[210:211], s[72:73], v[218:219] op_sel_hi:[1,0,1]
    v_pk_fma_f32 v[154:155], v[212:213], s[72:73], v[220:221] op_sel_hi:[1,0,1]
    v_pk_fma_f32 v[156:157], v[214:215], s[72:73], v[222:223] op_sel_hi:[1,0,1]
    v_pk_fma_f32 v[158:159], v[216:217], s[72:73], v[224:225] op_sel_hi:[1,0,1]
    v_pk_mul_f32 v[160:161], v[152:153], v[152:153]
    v_pk_mul_f32 v[162:163], v[154:155], v[154:155]
    v_pk_mul_f32 v[164:165], v[156:157], v[156:157]
    v_pk_mul_f32 v[166:167], v[158:159], v[158:159]
    v_pk_fma_f32 v[160:161], v[160:161], s[62:63], v[144:145] op_sel_hi:[1,0,1]
    v_pk_fma_f32 v[162:163], v[162:163], s[62:63], v[144:145] op_sel_hi:[1,0,1]
    v_pk_fma_f32 v[164:165], v[164:165], s[62:63], v[144:145] op_sel_hi:[1,0,1]
    v_pk_fma_f32 v[166:167], v[166:167], s[62:63], v[144:145] op_sel_hi:[1,0,1]
    v_pk_mul_f32 v[160:161], v[160:161], v[152:153]
    v_pk_mul_f32 v[162:163], v[162:163], v[154:155]
    v_pk_mul_f32 v[164:165], v[164:165], v[156:157]
    v_pk_mul_f32 v[166:167], v[166:167], v[158:159]
    v_exp_f32 v160, v160
    v_exp_f32 v161, v161
    v_exp_f32 v162, v162
    v_exp_f32 v163, v163
    v_exp_f32 v164, v164
    v_exp_f32 v165, v165
    v_exp_f32 v166, v166
    v_exp_f32 v167, v167
    v_pk_mul_f32 v[152:153], v[152:153], v[226:227]
    v_pk_mul_f32 v[154:155], v[154:155], v[228:229]
    v_pk_mul_f32 v[156:157], v[156:157], v[230:231]
    v_pk_mul_f32 v[158:159], v[158:159], v[232:233]
    v_pk_add_f32 v[160:161], v[160:161], 1.0 op_sel_hi:[1,0]
    v_pk_add_f32 v[162:163], v[162:163], 1.0 op_sel_hi:[1,0]
    v_pk_add_f32 v[164:165], v[164:165], 1.0 op_sel_hi:[1,0]
    v_pk_add_f32 v[166:167], v[166:167], 1.0 op_sel_hi:[1,0]
    v_rcp_f32 v160, v160
    v_rcp_f32 v161, v161
    v_rcp_f32 v162, v162
    v_rcp_f32 v163, v163
    v_rcp_f32 v164, v164
    v_rcp_f32 v165, v165
    v_rcp_f32 v166, v166
    v_rcp_f32 v167, v167
    v_pk_fma_f32 v[148:149], v[152:153], v[160:161], v[148:149]
    v_pk_fma_f32 v[148:149], v[154:155], v[162:163], v[148:149]
    v_pk_fma_f32 v[148:149], v[156:157], v[164:165], v[148:149]
    v_pk_fma_f32 v[148:149], v[158:159], v[166:167], v[148:149]
    v_pk_fma_f32 v[152:153], v[210:211], s[74:75], v[218:219] op_sel_hi:[1,0,1]
    v_pk_fma_f32 v[154:155], v[212:213], s[74:75], v[220:221] op_sel_hi:[1,0,1]
    v_pk_fma_f32 v[156:157], v[214:215], s[74:75], v[222:223] op_sel_hi:[1,0,1]
    v_pk_fma_f32 v[158:159], v[216:217], s[74:75], v[224:225] op_sel_hi:[1,0,1]
    v_pk_mul_f32 v[160:161], v[152:153], v[152:153]
    v_pk_mul_f32 v[162:163], v[154:155], v[154:155]
    v_pk_mul_f32 v[164:165], v[156:157], v[156:157]
    v_pk_mul_f32 v[166:167], v[158:159], v[158:159]
    v_pk_fma_f32 v[160:161], v[160:161], s[62:63], v[144:145] op_sel_hi:[1,0,1]
    v_pk_fma_f32 v[162:163], v[162:163], s[62:63], v[144:145] op_sel_hi:[1,0,1]
    v_pk_fma_f32 v[164:165], v[164:165], s[62:63], v[144:145] op_sel_hi:[1,0,1]
    v_pk_fma_f32 v[166:167], v[166:167], s[62:63], v[144:145] op_sel_hi:[1,0,1]
    v_pk_mul_f32 v[160:161], v[160:161], v[152:153]
    v_pk_mul_f32 v[162:163], v[162:163], v[154:155]
    v_pk_mul_f32 v[164:165], v[164:165], v[156:157]
    v_pk_mul_f32 v[166:167], v[166:167], v[158:159]
    v_exp_f32 v160, v160
    v_exp_f32 v161, v161
    v_exp_f32 v162, v162
    v_exp_f32 v163, v163
    v_exp_f32 v164, v164
    v_exp_f32 v165, v165
    v_exp_f32 v166, v166
    v_exp_f32 v167, v167
    v_pk_mul_f32 v[152:153], v[152:153], v[226:227]
    v_pk_mul_f32 v[154:155], v[154:155], v[228:229]
    v_pk_mul_f32 v[156:157], v[156:157], v[230:231]
    v_pk_mul_f32 v[158:159], v[158:159], v[232:233]
    v_pk_add_f32 v[160:161], v[160:161], 1.0 op_sel_hi:[1,0]
    v_pk_add_f32 v[162:163], v[162:163], 1.0 op_sel_hi:[1,0]
    v_pk_add_f32 v[164:165], v[164:165], 1.0 op_sel_hi:[1,0]
    v_pk_add_f32 v[166:167], v[166:167], 1.0 op_sel_hi:[1,0]
    v_rcp_f32 v160, v160
    v_rcp_f32 v161, v161
    v_rcp_f32 v162, v162
    v_rcp_f32 v163, v163
    v_rcp_f32 v164, v164
    v_rcp_f32 v165, v165
    v_rcp_f32 v166, v166
    v_rcp_f32 v167, v167
    v_pk_fma_f32 v[150:151], v[152:153], v[160:161], v[150:151]
    v_pk_fma_f32 v[150:151], v[154:155], v[162:163], v[150:151]
    v_pk_fma_f32 v[150:151], v[156:157], v[164:165], v[150:151]
    v_pk_fma_f32 v[150:151], v[158:159], v[166:167], v[150:151]
    v_add_f32 v146, v146, v147
    v_add_f32 v148, v148, v149
    v_add_f32 v150, v150, v151
    v_add_f32_dpp v146, v146, v146 quad_perm:[1,0,3,2] row_mask:0xf bank_mask:0xf
    v_add_f32_dpp v148, v148, v148 quad_perm:[1,0,3,2] row_mask:0xf bank_mask:0xf
    v_add_f32_dpp v150, v150, v150 quad_perm:[1,0,3,2] row_mask:0xf bank_mask:0xf
    v_add_f32_dpp v146, v146, v146 quad_perm:[2,3,0,1] row_mask:0xf bank_mask:0xf
    v_add_f32_dpp v148, v148, v148 quad_perm:[2,3,0,1] row_mask:0xf bank_mask:0xf
    v_add_f32_dpp v150, v150, v150 quad_perm:[2,3,0,1] row_mask:0xf bank_mask:0xf
    v_add_f32_dpp v146, v146, v146 row_half_mirror row_mask:0xf bank_mask:0xf
    v_add_f32_dpp v148, v148, v148 row_half_mirror row_mask:0xf bank_mask:0xf
    v_add_f32_dpp v150, v150, v150 row_half_mirror row_mask:0xf bank_mask:0xf
    v_add_f32_dpp v146, v146, v146 row_mirror row_mask:0xf bank_mask:0xf
    v_add_f32_dpp v148, v148, v148 row_mirror row_mask:0xf bank_mask:0xf
    v_add_f32_dpp v150, v150, v150 row_mirror row_mask:0xf bank_mask:0xf
    v_mov_b32 v147, v146
    v_mov_b32 v149, v148
    v_mov_b32 v151, v150
    v_permlane16_swap_b32 v146, v147
    v_permlane16_swap_b32 v148, v149
    v_permlane16_swap_b32 v150, v151
    v_add_f32 v146, v146, v147
    v_add_f32 v148, v148, v149
    v_add_f32 v150, v150, v151
    v_mov_b32 v147, v146
    v_mov_b32 v149, v148
    v_mov_b32 v151, v150
    v_permlane32_swap_b32 v146, v147
    v_permlane32_swap_b32 v148, v149
    v_permlane32_swap_b32 v150, v151
    v_add_f32 v146, v146, v147
    v_add_f32 v148, v148, v149
    v_add_f32 v150, v150, v151
    s_lshl_b32 s62, s57, 4
    s_add_u32 s62, s62, 148224
    v_mov_b32 v15, s62
    v_mov_b32 v147, v148
    v_mov_b32 v148, v150
    s_mov_b64 exec, 1
    ds_write_b96 v15, v[146:148]
    s_mov_b64 exec, -1
    s_waitcnt lgkmcnt(0)
    s_barrier
    s_cmp_eq_u32 s57, 0
    s_cbranch_scc0 L_fin
    v_lshlrev_b32 v15, 2, v1
    v_add_u32 v15, 148224, v15
    ds_read_b32 v100, v15
    ds_read_b32 v101, v15 offset:16
    ds_read_b32 v102, v15 offset:32
    ds_read_b32 v103, v15 offset:48
    s_mov_b32 s52, s26
    s_mov_b32 s53, s27
    s_mov_b32 s54, 1280
    s_mov_b32 s55, 0x00020000
    v_add_u32 v15, s64, v1
    v_lshlrev_b32 v16, 1, v15
    v_add_f32 v136, v136, v208
    s_waitcnt lgkmcnt(0)
    v_add_f32 v100, v100, v101
    v_add_f32 v102, v102, v103
    v_add_f32 v100, v100, v102
    v_add_f32 v100, v100, v136
    v_cvt_pk_bf16_f32 v100, v100, v100
    v_cmp_gt_u32 vcc, 640, v15
    s_nop 0
    s_and_b64 exec, vcc, 7
    s_cbranch_execz L_fin
    buffer_store_short v100, v16, s[52:55], 0 offen
L_fin:
L_end:
    s_endpgm
L_code_end:
.set CODE_BYTES, L_code_end - sequential_preLN__compressed_kv_cla__mixer_token_mlp__decode_kernel
.section .rodata,"a"
.p2align 6
.amdhsa_kernel sequential_preLN__compressed_kv_cla__mixer_token_mlp__decode_kernel
.amdhsa_next_free_vgpr 512
.amdhsa_next_free_sgpr 102
.amdhsa_accum_offset 256
.amdhsa_group_segment_fixed_size 0
.amdhsa_kernarg_size 112
.amdhsa_user_sgpr_count 2
.amdhsa_user_sgpr_kernarg_segment_ptr 1
.amdhsa_system_sgpr_workgroup_id_x 1
.end_amdhsa_kernel
```
